```python
import torch

def _softmax(x, axis=-1):
    return torch.softmax(x, dim=axis)
def _gelu(x):
    return torch.nn.functional.gelu(x, approximate="tanh")
def _silu(x):
    return torch.nn.functional.silu(x)
def _sigmoid(x):
    return torch.sigmoid(x)
def _layernorm(x, axis=-1, eps=1e-5):
    m = x.mean(dim=axis, keepdim=True)
    v = x.var(dim=axis, keepdim=True, unbiased=False)
    return (x - m) / torch.sqrt(v + eps)
def _scatter_add(tgt, idx, src, axis=0):
    return tgt.clone().index_add_(axis, idx, src)
def _segment_sum(src, seg, n):
    out = torch.zeros((n,) + src.shape[1:], dtype=src.dtype)
    return out.index_add_(0, seg, src)
def _pad(x, pw):
    flat = tuple(v for pair in reversed(pw) for v in pair)
    return torch.nn.functional.pad(x, flat)

kernel_name = 'gated_mix__grouped_kv_mqa__moe_arch_mod__prompt'

def setup_inputs():

    _w = (lambda a: (lambda t: t.to(torch.bfloat16) if t.is_floating_point() else t)(torch.as_tensor(a)))
    def _A_setup():
        B, S, D, H = 1, 2048, 640, 32
        Dh = D // H
        return {
            "x": _w((lambda *s: torch.randn(*s, dtype=torch.bfloat16) * 0.05)(B, S, D)),
            "wq": _w((lambda *s: torch.randn(*s, dtype=torch.bfloat16) * 3.2)(D, H * Dh)),
            "wk": _w((lambda *s: torch.randn(*s, dtype=torch.bfloat16) * 3.2)(D, Dh)),
            "wv": _w((lambda *s: torch.randn(*s, dtype=torch.bfloat16) * 0.4)(D, Dh)),
            "wo": _w((lambda *s: torch.randn(*s, dtype=torch.bfloat16) * 0.4)(H * Dh, D)),
        }
    _A_in = _A_setup()

    def _B_setup():
        B, S, D, F, C = 1, 2048, 640, 1728, 1
        return {
            "x": _w((lambda *s: torch.randn(*s, dtype=torch.bfloat16) * 0.05)(B, S, D)),
            "w_r": _w((lambda *s: torch.randn(*s, dtype=torch.bfloat16) * 1.6)(D)),
            "w_gate": _w((lambda *s: torch.randn(*s, dtype=torch.bfloat16) * 0.8)(D, F)),
            "w_up": _w((lambda *s: torch.randn(*s, dtype=torch.bfloat16) * 0.8)(D, F)),
            "w_down": _w((lambda *s: torch.randn(*s, dtype=torch.bfloat16) * 0.8)(F, D)),
        }
    _B_in = _B_setup()

    return {
        "A_x": _A_in["x"],
        "A_wq": _A_in["wq"],
        "A_wk": _A_in["wk"],
        "A_wv": _A_in["wv"],
        "A_wo": _A_in["wo"],
        "B_x": _B_in["x"],
        "B_w_r": _B_in["w_r"],
        "B_w_gate": _B_in["w_gate"],
        "B_w_up": _B_in["w_up"],
        "B_w_down": _B_in["w_down"],
        "gate_w": _w((lambda *s: torch.randn(*s, dtype=torch.bfloat16) * 0.05)(640) * 16.0),
    }

def reference(A_x, A_wq, A_wk, A_wv, A_wo, B_x, B_w_r, B_w_gate, B_w_up, B_w_down, gate_w):
    def _A_ref(x, wq, wk, wv, wo):
        B, S, D = x.shape
        H = 32
        Dh = D // H
        q = (lambda x, *d: x.permute(*d))((x @ wq).reshape(B, S, H, Dh), 0, 2, 1, 3)
        k = x @ wk
        v = x @ wv
        scores = torch.einsum("bhqd,bkd->bhqk", q, k) * (Dh ** -0.5)
        p = _softmax(scores, axis=-1)
        o = torch.einsum("bhqk,bkd->bhqd", p, v)
        return (lambda x, *d: x.permute(*d))(o, 0, 2, 1, 3).reshape(B, S, H * Dh) @ wo

    def _B_ref(x, w_r, w_gate, w_up, w_down):
        B, S, D = x.shape
        C = 1
        r = x @ w_r
        idx = torch.argsort(-r, axis=-1)[:, :C]
        idx_e = (lambda x, n, axis: torch.repeat_interleave(x, n, dim=axis))(idx.reshape(B, C, 1), D, axis=2)
        x_sel = (lambda x, i, axis: torch.take_along_dim(x, i, dim=axis))(x, idx_e, axis=1)
        g = _silu(x_sel @ w_gate)
        u = x_sel @ w_up
        y = (g * u) @ w_down
        r_sel = _sigmoid((lambda x, i, axis: torch.take_along_dim(x, i, dim=axis))(r, idx, axis=1))
        y = y * r_sel.reshape(B, C, 1)
        b_off = (torch.arange(B) * S).reshape(B, 1)
        flat_idx = (idx + b_off).reshape(B * C)
        zero = (x * 0.0).reshape(B * S, D)
        upd = _scatter_add(zero, flat_idx, y.reshape(B * C, D), axis=0)
        return x + upd.reshape(B, S, D)

    x = A_x
    g = _sigmoid((x * gate_w).sum(-1, keepdims=True))
    a = _A_ref(x, A_wq, A_wk, A_wv, A_wo)
    b = _B_ref(x, B_w_r, B_w_gate, B_w_up, B_w_down)
    return g * a + (1 - g) * b
```

```asm
; @launch grid=(256,1,1) block=(512,1,1) lds=163840
.amdgcn_target "amdgcn-amd-amdhsa--gfx950"
.text
.p2align 12
.globl gated_mix__grouped_kv_mqa__moe_arch_mod__prompt_kernel
.p2align 8
.type gated_mix__grouped_kv_mqa__moe_arch_mod__prompt_kernel,@function
gated_mix__grouped_kv_mqa__moe_arch_mod__prompt_kernel:
    v_readfirstlane_b32 s4, v0
    s_cmp_ge_u32 s2, 256
    s_cbranch_scc1 k_end
    s_cmp_eq_u32 s4, 384
    s_cbranch_scc1 k_zero
k_go:
    s_load_dwordx16 s[64:79], s[0:1], 0
    s_load_dwordx8 s[80:87], s[0:1], 64
    s_load_dwordx4 s[88:91], s[0:1], 96
    s_getpc_b64 s[50:51]
k_pc:
    s_bfe_u32 s40, s2, 0x30003
    v_lshrrev_b32 v2, 3, v0
    v_lshl_add_u32 v2, v2, 3, s40
    v_lshlrev_b32 v2, 7, v2
    v_min_u32 v2, k_last-k_pc-4, v2
    s_mov_b32 exec_lo, 0x01010101
    s_mov_b32 exec_hi, 0x01010101
    global_load_dword v252, v2, s[50:51]
    s_mov_b64 exec, -1
    v_and_b32 v231, 63, v0
    s_lshr_b32 s4, s4, 6
    s_and_b32 s5, s2, 7
    s_lshl_b32 s5, s5, 2
    s_lshr_b32 s32, s2, 6
    s_or_b32 s5, s5, s32
    s_bfe_u32 s6, s2, 0x30003
    s_lshr_b32 s33, s6, 1
    s_and_b32 s7, s4, 3
    s_lshr_b32 s3, s4, 2
    s_add_u32 s32, s32, s6
    s_and_b32 s41, s2, 7
    s_add_u32 s32, s32, s41
    s_mul_i32 s41, s32, 52
    s_lshr_b32 s41, s41, 8
    s_mul_i32 s41, s41, 5
    s_sub_u32 s32, s32, s41
    v_lshlrev_b32 v200, 4, v231
    v_and_b32 v255, 3, v0
    v_lshlrev_b32 v255, 2, v255
    v_add_u32 v240, 110080, v255
    v_add_u32 v255, 112640, v255
    s_barrier
    s_cmp_eq_u32 s4, 7
    s_cbranch_scc1 f_w7
    v_lshrrev_b32 v204, 3, v231
    v_mul_u32_u24 v232, 1280, v204
    v_lshrrev_b32 v204, 4, v231
    v_xor_b32 v204, v204, v231
    v_and_b32 v204, 7, v204
    v_lshl_add_u32 v232, v204, 4, v232
    s_mul_i32 s42, s5, 81920
    s_cmp_lt_u32 s4, 5
    s_cbranch_scc0 f_w567
    s_setprio 3
    v_xor_b32 v233, 64, v232
    s_add_u32 s43, s32, s4
    s_cmp_ge_u32 s43, 5
    s_cselect_b32 s47, 5, 0
    s_sub_u32 s43, s43, s47
    s_mul_i32 s46, s33, 20480
    s_add_u32 s46, s46, s42
    s_lshl_b32 s41, s43, 8
    s_add_u32 s46, s46, s41
    s_lshl_b32 s44, s33, 11
    s_lshl_b32 s41, s4, 14
    s_add_u32 s44, s44, s41
    s_mul_i32 s42, s4, 3072
    s_add_u32 s42, s42, 107520
    s_waitcnt lgkmcnt(0)
    s_mov_b32 s8, s64
    s_and_b32 s9, s65, 0xffff
    s_mov_b32 s10, 2621440
    s_mov_b32 s11, 0x20000
    s_mov_b32 m0, s44
    s_add_u32 s41, s46, 128
    buffer_load_dwordx4 v232, s[8:11], s46 offen  lds
    s_add_u32 m0, s44, 8192
    s_add_u32 s40, s46, 10240
    buffer_load_dwordx4 v232, s[8:11], s41 offen  lds
    s_add_u32 m0, s44, 1024
    s_add_u32 s41, s40, 128
    buffer_load_dwordx4 v233, s[8:11], s40 offen  lds
    s_add_u32 m0, s44, 9216
    s_nop 0
    buffer_load_dwordx4 v233, s[8:11], s41 offen  lds
    s_bitcmp1_b32 s6, 0
    s_cselect_b32 s68, s70, s68
    s_cselect_b32 s69, s71, s69
    s_mov_b32 s16, s68
    s_and_b32 s17, s69, 0xffff
    s_mov_b32 s18, 25600
    s_mov_b32 s19, 0x20000
    s_mul_i32 s40, s43, 5120
    s_mul_i32 s41, s4, 5120
    s_add_u32 m0, s41, 81920
    s_add_u32 s45, s40, 4096
    buffer_load_dwordx4 v200, s[16:19], s40 offen  lds
    buffer_load_dwordx4 v200, s[16:19], s40 offen offset:1024  lds
    buffer_load_dwordx4 v200, s[16:19], s40 offen offset:2048  lds
    buffer_load_dwordx4 v200, s[16:19], s40 offen offset:3072  lds
    s_add_u32 m0, s41, 86016
    s_nop 0
    buffer_load_dwordx4 v200, s[16:19], s45 offen  lds
    s_bitcmp1_b32 s6, 0
    s_cbranch_scc1 f_norg
    s_lshl_b32 s40, s43, 8
    v_and_b32 v206, 0xf0, v200
    v_add_u32 v206, s40, v206
    v_mov_b32 v207, 0
    v_lshl_add_u64 v[204:205], s[84:85], 0, v[206:207]
    s_mov_b64 exec, 0xffff
    v_lshl_add_u64 v[204:205], s[76:77], 0, v[206:207]
    s_mov_b32 m0, s42
    s_mov_b32 exec_lo, -1
    global_load_lds_dwordx4 v[204:205], off
    s_mov_b64 exec, -1
f_norg:
    v_mov_b32 v210, 1
    s_mov_b64 exec, 1
    ds_add_u32 v240, v210
    s_mov_b64 exec, -1
    s_branch f_c1
k_zero:
    v_mov_b32 v1, 110080
    v_mov_b64 v[2:3], 0
    v_mov_b64 v[4:5], 0
    ds_write_b128 v1, v[2:5]
    ds_write_b128 v1, v[2:5] offset:16
    s_waitcnt lgkmcnt(0)
    s_branch k_go
f_w7:
    s_setprio 3
    v_mov_b64 v[0:1], 0
    v_mov_b64 v[2:3], 0
    v_lshlrev_b32 v211, 7, v231
    s_mul_i32 s40, s2, 320
    s_add_u32 s40, s40, 262144
    s_mov_b32 s41, 196608
    s_waitcnt lgkmcnt(0)
    s_mov_b32 s20, s90
    s_and_b32 s21, s91, 0xffff
    s_mov_b32 s22, 524288
    s_mov_b32 s23, 0x20000
    s_mov_b64 exec, 0xfffff
    buffer_store_dwordx4 v[0:3], v200, s[20:23], s40 offen sc1
    s_mov_b64 exec, -1
    s_cmp_eq_u32 s2, 0
    s_cbranch_scc0 f_w7a
    buffer_store_dwordx4 v[0:3], v211, s[20:23], s41 offen sc1
f_w7a:
    s_cmp_eq_u32 s2, 0
    s_cbranch_scc0 f_w7b
    s_waitcnt vmcnt(0)
    s_atomic_or s41, s[88:89], 0
    s_branch f_w7b
f_c1:
    s_call_b64 s[92:93], c_setup
    v_mov_b64 v[216:217], 0
    v_mov_b32 v218, 0
    s_cmp_eq_u32 s4, 4
    s_cbranch_scc1 f_ns
    v_bfe_u32 v232, v231, 3, 1
    v_lshlrev_b32 v232, 10, v232
    v_and_b32 v205, 7, v231
    v_lshl_add_u32 v232, v205, 7, v232
    v_bfe_u32 v205, v231, 1, 3
    v_lshrrev_b32 v206, 4, v231
    v_xor_b32 v205, v205, v206
    v_lshl_add_u32 v232, v205, 4, v232
    s_lshl_b32 s40, s7, 11
    v_add_u32 v232, s40, v232
    v_xor_b32 v233, 64, v232
    v_and_b32 v205, 31, v231
    v_lshrrev_b32 v206, 5, v231
    v_mul_u32_u24 v206, 5120, v206
    v_lshl_add_u32 v169, v205, 4, v206
    v_mov_b32 v168, 0xdddd
    v_cmp_gt_u32 vcc, 20, v205
    v_lshlrev_b32 v206, 4, v205
    v_add_u32 v206, 110592, v206
    v_cndmask_b32 v138, v206, v169, vcc
    v_cndmask_b32 v139, 0, 1, vcc
    v_mov_b64 v[64:65], 0
    v_mov_b64 v[66:67], 0
    v_mov_b64 v[68:69], 0
    v_mov_b64 v[70:71], 0
    v_mov_b64 v[72:73], 0
    v_mov_b64 v[74:75], 0
    v_mov_b64 v[76:77], 0
    v_mov_b64 v[78:79], 0
    v_mov_b64 v[80:81], 0
    v_mov_b64 v[82:83], 0
    v_mov_b64 v[84:85], 0
    v_mov_b64 v[86:87], 0
    v_mov_b64 v[88:89], 0
    v_mov_b64 v[90:91], 0
    v_mov_b64 v[92:93], 0
    v_mov_b64 v[94:95], 0
    v_lshrrev_b32 v205, 2, v231
    v_mul_u32_u24 v205, 160, v205
    v_and_b32 v206, 1, v231
    v_mul_u32_u24 v206, 80, v206
    v_add_u32 v205, v205, v206
    v_bfe_u32 v206, v231, 1, 1
    v_lshl_add_u32 v205, v206, 3, v205
    v_add_u32 v234, 122880, v205
    v_add_u32 v235, 81920, v205
    v_lshl_add_u32 v236, v206, 5, v234
    v_lshl_add_u32 v237, v206, 5, v235
    v_and_b32 v206, 15, v231
    v_and_b32 v207, 48, v231
    v_bfe_u32 v170, v231, 4, 1
    v_lshlrev_b32 v170, 9, v170
    v_lshl_add_u32 v170, v206, 4, v170
    v_lshrrev_b32 v206, 5, v231
    v_lshl_add_u32 v170, v206, 8, v170
    s_mul_i32 s40, s7, 5120
    s_add_u32 s40, s40, 116224
    v_add_u32 v223, s40, v200
    s_mul_i32 s40, s7, 2816
    s_add_u32 s40, s40, 136704
    v_and_b32 v205, 15, v231
    v_mul_u32_u24 v205, 176, v205
    v_lshrrev_b32 v206, 1, v207
    v_add3_u32 v222, v205, v206, s40
    v_add_u32 v205, 0, v231
    v_mul_u32_u24 v206, 6554, v205
    v_lshrrev_b32 v206, 16, v206
    v_add_u32 v208, v205, v206
    v_lshl_add_u32 v219, v208, 4, s40
    v_mul_u32_u24 v206, 1120, v206
    v_lshl_add_u32 v216, v205, 4, v206
    v_add_u32 v205, 64, v231
    v_mul_u32_u24 v206, 6554, v205
    v_lshrrev_b32 v206, 16, v206
    v_add_u32 v208, v205, v206
    v_lshl_add_u32 v220, v208, 4, s40
    v_mul_u32_u24 v206, 1120, v206
    v_lshl_add_u32 v217, v205, 4, v206
    v_add_u32 v205, 128, v231
    v_mul_u32_u24 v206, 6554, v205
    v_lshrrev_b32 v206, 16, v206
    v_add_u32 v208, v205, v206
    v_lshl_add_u32 v221, v208, 4, s40
    v_mul_u32_u24 v206, 1120, v206
    v_lshl_add_u32 v218, v205, 4, v206
    s_mul_i32 s42, s5, 81920
    s_mul_i32 s40, s7, 20480
    s_add_u32 s42, s42, s40
    s_lshl_b32 s40, s62, 11
    s_add_u32 s56, s42, s40
    s_add_u32 s56, s56, 16384
    s_lshl2_add_u32 s42, s40, s42
    s_add_u32 s40, s32, 0
    s_and_b32 s40, s40, 3
    s_lshl_b32 s40, s40, 11
    s_add_u32 s52, s40, s42
    s_add_u32 s40, s32, 1
    s_and_b32 s40, s40, 3
    s_lshl_b32 s40, s40, 11
    s_add_u32 s53, s40, s42
    s_add_u32 s40, s32, 2
    s_and_b32 s40, s40, 3
    s_lshl_b32 s40, s40, 11
    s_add_u32 s54, s40, s42
    s_add_u32 s40, s32, 3
    s_and_b32 s40, s40, 3
    s_lshl_b32 s40, s40, 11
    s_add_u32 s55, s40, s42
f_ns:
    s_mul_i32 s42, s4, 3072
    s_add_u32 s42, s42, 107520
    v_bfe_u32 v204, v231, 3, 1
    v_lshlrev_b32 v204, 10, v204
    v_and_b32 v205, 7, v231
    v_lshl_add_u32 v204, v205, 7, v204
    v_bfe_u32 v205, v231, 1, 3
    v_lshrrev_b32 v206, 4, v231
    v_xor_b32 v205, v205, v206
    v_lshl_add_u32 v204, v205, 4, v204
    v_add_u32 v204, s44, v204
    v_xor_b32 v205, 64, v204
    v_and_b32 v208, 1, v231
    v_lshlrev_b32 v208, 8, v208
    v_lshl_add_u32 v208, v206, 4, v208
    v_add_u32 v208, s42, v208
    v_lshlrev_b32 v206, 3, v206
    v_bfe_u32 v207, v231, 2, 2
    v_add_u32 v206, v206, v207
    v_mul_u32_u24 v206, 40, v206
    v_and_b32 v207, 3, v231
    v_lshl_add_u32 v206, v207, 3, v206
    s_mul_i32 s40, s4, 5120
    s_add_u32 s40, s40, 81920
    v_add_u32 v206, s40, v206
    v_add_u32 v207, s42, v200
    v_mov_b32 v210, 1
    s_waitcnt vmcnt(0)
    ds_read_b128 v[48:51], v204 offset:0
    ds_read_b64_tr_b16 v[0:1], v206 offset:0
    ds_read_b64_tr_b16 v[2:3], v206 offset:160
    ds_read_b64_tr_b16 v[4:5], v206 offset:8
    ds_read_b64_tr_b16 v[6:7], v206 offset:168
    ds_read_b128 v[52:55], v205 offset:0
    ds_read_b64_tr_b16 v[8:9], v206 offset:1280
    ds_read_b64_tr_b16 v[10:11], v206 offset:1440
    ds_read_b64_tr_b16 v[12:13], v206 offset:1288
    ds_read_b64_tr_b16 v[14:15], v206 offset:1448
    ds_read_b128 v[56:59], v204 offset:8192
    ds_read_b64_tr_b16 v[16:17], v206 offset:2560
    ds_read_b64_tr_b16 v[18:19], v206 offset:2720
    ds_read_b64_tr_b16 v[20:21], v206 offset:2568
    ds_read_b64_tr_b16 v[22:23], v206 offset:2728
    ds_read_b128 v[60:63], v205 offset:8192
    ds_read_b64_tr_b16 v[24:25], v206 offset:3840
    ds_read_b64_tr_b16 v[26:27], v206 offset:4000
    ds_read_b64_tr_b16 v[28:29], v206 offset:3848
    ds_read_b64_tr_b16 v[30:31], v206 offset:4008
    s_bitcmp1_b32 s6, 0
    s_cbranch_scc1 f_mv
    ds_read_b128 v[32:35], v208 offset:0
    ds_read_b128 v[36:39], v208 offset:64
    ds_read_b128 v[40:43], v208 offset:128
    ds_read_b128 v[44:47], v208 offset:192
    s_waitcnt lgkmcnt(15)
    v_mfma_f32_16x16x32_bf16 v[96:99], v[0:3], v[48:51], 0
    v_mfma_f32_16x16x32_bf16 v[100:103], v[4:7], v[48:51], 0
    s_waitcnt lgkmcnt(14)
    v_mfma_f32_16x16x32_bf16 v[96:99], v[8:11], v[52:55], v[96:99]
    v_mfma_f32_16x16x32_bf16 v[100:103], v[12:15], v[52:55], v[100:103]
    s_waitcnt lgkmcnt(9)
    v_mfma_f32_16x16x32_bf16 v[96:99], v[16:19], v[56:59], v[96:99]
    v_mfma_f32_16x16x32_bf16 v[100:103], v[20:23], v[56:59], v[100:103]
    s_waitcnt lgkmcnt(4)
    v_mfma_f32_16x16x32_bf16 v[96:99], v[24:27], v[60:63], v[96:99]
    v_mfma_f32_16x16x32_bf16 v[100:103], v[28:31], v[60:63], v[100:103]
    s_waitcnt lgkmcnt(0)
    v_mfma_f32_16x16x32_bf16 v[104:107], v[32:35], v[48:51], 0
    v_mfma_f32_16x16x32_bf16 v[104:107], v[36:39], v[52:55], v[104:107]
    v_mfma_f32_16x16x32_bf16 v[104:107], v[40:43], v[56:59], v[104:107]
    v_mfma_f32_16x16x32_bf16 v[104:107], v[44:47], v[60:63], v[104:107]
    s_branch f_md
f_mv:
    s_waitcnt lgkmcnt(15)
    v_mfma_f32_16x16x32_bf16 v[96:99], v[48:51], v[0:3], 0
    v_mfma_f32_16x16x32_bf16 v[100:103], v[48:51], v[4:7], 0
    s_waitcnt lgkmcnt(10)
    v_mfma_f32_16x16x32_bf16 v[96:99], v[52:55], v[8:11], v[96:99]
    v_mfma_f32_16x16x32_bf16 v[100:103], v[52:55], v[12:15], v[100:103]
    s_waitcnt lgkmcnt(5)
    v_mfma_f32_16x16x32_bf16 v[96:99], v[56:59], v[16:19], v[96:99]
    v_mfma_f32_16x16x32_bf16 v[100:103], v[56:59], v[20:23], v[100:103]
    s_waitcnt lgkmcnt(0)
    v_mfma_f32_16x16x32_bf16 v[96:99], v[60:63], v[24:27], v[96:99]
    v_mfma_f32_16x16x32_bf16 v[100:103], v[60:63], v[28:31], v[100:103]
    s_nop 4
f_md:
    s_nop 2
    ds_write_b128 v207, v[96:99]
    ds_write_b128 v207, v[100:103] offset:1024
    s_mov_b64 exec, 0xffff
    s_nop 0
    ds_write_b128 v207, v[104:107] offset:2048
    s_mov_b64 exec, 1
    ds_add_u32 v240, v210
    s_mov_b64 exec, -1
    s_setprio 3
    s_cmp_eq_u32 s4, 4
    s_cbranch_scc1 f_w4
    v_mov_b32 v211, 1
    s_lshl_b64 s[38:39], 1, s7
    s_cmp_eq_u32 s37, 0
    s_cbranch_scc0 h_skipq
    s_mov_b32 s37, 2
    s_branch q_pad1
a_back_q1:
    s_branch q_pad2
a_back_q2:
    s_branch q_pad3
a_back_q3:
    s_branch q_pad4
a_back_q4:
    s_branch q_pad5
a_back_q5:
    s_branch q_pad6
a_back_q6:
    s_branch q_pad7
a_back_q7:
    s_branch q_pad8
a_back_q8:
    s_branch q_pad9
a_back_q9:
    s_branch q_pad10
a_back_q10:
    s_branch q_pad11
a_back_q11:
    s_mov_b32 s37, 0
h_skipq:
    s_branch q_go
q_w4:
    s_mov_b32 s46, 8000000
q_s4_sp:
    ds_read_b32 v215, v240 offset:0
    s_waitcnt lgkmcnt(0)
    v_cmp_gt_u32 vcc, 2, v215
    s_sub_u32 s46, s46, 1
    s_cselect_b32 s40, 0, 12
    s_and_b32 s40, vcc_lo, s40
    s_cbranch_scc1 q_s4_sp
q_s4_ok:
    s_branch q_r4
q_w8:
    s_mov_b32 s46, 8000000
q_s8_sp:
    ds_read_b32 v215, v240 offset:0
    s_waitcnt lgkmcnt(0)
    v_cmp_gt_u32 vcc, 3, v215
    s_sub_u32 s46, s46, 1
    s_cselect_b32 s40, 0, 12
    s_and_b32 s40, vcc_lo, s40
    s_cbranch_scc1 q_s8_sp
q_s8_ok:
    s_branch q_r8
q_w12:
    s_mov_b32 s46, 8000000
q_s12_sp:
    ds_read_b32 v215, v240 offset:0
    s_waitcnt lgkmcnt(0)
    v_cmp_gt_u32 vcc, 4, v215
    s_sub_u32 s46, s46, 1
    s_cselect_b32 s40, 0, 12
    s_and_b32 s40, vcc_lo, s40
    s_cbranch_scc1 q_s12_sp
q_s12_ok:
    s_branch q_r12
q_w14:
    s_mov_b32 s46, 8000000
q_s14_sp:
    ds_read_b32 v215, v240 offset:0
    s_waitcnt lgkmcnt(0)
    v_cmp_gt_u32 vcc, 5, v215
    s_sub_u32 s46, s46, 1
    s_cselect_b32 s40, 0, 12
    s_and_b32 s40, vcc_lo, s40
    s_cbranch_scc1 q_s14_sp
q_s14_ok:
    s_branch q_r14
q_w16:
    s_mov_b32 s46, 8000000
q_s16_sp:
    ds_read_b32 v215, v240 offset:0
    s_waitcnt lgkmcnt(0)
    v_cmp_gt_u32 vcc, 6, v215
    s_sub_u32 s46, s46, 1
    s_cselect_b32 s40, 0, 12
    s_and_b32 s40, vcc_lo, s40
    s_cbranch_scc1 q_s16_sp
q_s16_ok:
    s_branch q_r16
q_w18:
    s_mov_b32 s46, 8000000
q_s18_sp:
    ds_read_b32 v215, v240 offset:0
    s_waitcnt lgkmcnt(0)
    v_cmp_gt_u32 vcc, 7, v215
    s_sub_u32 s46, s46, 1
    s_cselect_b32 s40, 0, 12
    s_and_b32 s40, vcc_lo, s40
    s_cbranch_scc1 q_s18_sp
q_s18_ok:
    s_branch q_r18
q_go:
    s_mov_b32 s46, 8000000
q_0_sp:
    ds_read_b32 v215, v240 offset:0
    s_waitcnt lgkmcnt(0)
    v_cmp_gt_u32 vcc, 1, v215
    s_sub_u32 s46, s46, 1
    s_cselect_b32 s40, 0, 12
    s_and_b32 s40, vcc_lo, s40
    s_cbranch_scc1 q_0_sp
q_0_ok:
    ds_read_b128 v[0:3], v232 offset:0
    ds_read_b64_tr_b16 v[16:17], v234 offset:0
    ds_read_b64_tr_b16 v[18:19], v234 offset:2560
    ds_read_b64_tr_b16 v[20:21], v234 offset:16
    ds_read_b64_tr_b16 v[22:23], v234 offset:2576
    ds_read_b64_tr_b16 v[24:25], v234 offset:40
    ds_read_b64_tr_b16 v[26:27], v234 offset:2600
    ds_read_b64_tr_b16 v[28:29], v234 offset:56
    ds_read_b64_tr_b16 v[30:31], v234 offset:2616
    ds_read_b64_tr_b16 v[32:33], v236 offset:32
    ds_read_b64_tr_b16 v[34:35], v236 offset:2592
    ds_read_b128 v[4:7], v233 offset:0
    ds_read_b64_tr_b16 v[36:37], v234 offset:5120
    ds_read_b64_tr_b16 v[38:39], v234 offset:7680
    ds_read_b64_tr_b16 v[40:41], v234 offset:5136
    ds_read_b64_tr_b16 v[42:43], v234 offset:7696
    s_waitcnt lgkmcnt(13)
q_pad1:
    s_cmp_eq_u32 s37, 2
    s_cbranch_scc1 a_back_q1
    ds_read_b64_tr_b16 v[44:45], v234 offset:5160
    ds_read_b64_tr_b16 v[46:47], v234 offset:7720
    v_mfma_f32_16x16x32_bf16 v[172:175], v[16:19], v[0:3], 0
    s_waitcnt lgkmcnt(13)
    ds_read_b64_tr_b16 v[48:49], v234 offset:5176
    ds_read_b64_tr_b16 v[50:51], v234 offset:7736
    v_mfma_f32_16x16x32_bf16 v[176:179], v[20:23], v[0:3], 0
    s_waitcnt lgkmcnt(13)
    ds_read_b64_tr_b16 v[52:53], v236 offset:5152
    ds_read_b64_tr_b16 v[54:55], v236 offset:7712
    v_mfma_f32_16x16x32_bf16 v[180:183], v[24:27], v[0:3], 0
    s_waitcnt lgkmcnt(13)
    ds_read_b128 v[8:11], v232 offset:8192
    ds_read_b64_tr_b16 v[16:17], v234 offset:10240
    ds_read_b64_tr_b16 v[18:19], v234 offset:12800
    v_mfma_f32_16x16x32_bf16 v[184:187], v[28:31], v[0:3], 0
    s_waitcnt lgkmcnt(13)
    ds_read_b64_tr_b16 v[20:21], v234 offset:10256
    ds_read_b64_tr_b16 v[22:23], v234 offset:12816
    v_mfma_f32_16x16x32_bf16 v[188:191], v[32:35], v[0:3], 0
    s_waitcnt lgkmcnt(13)
    ds_read_b64_tr_b16 v[24:25], v234 offset:10280
    ds_read_b64_tr_b16 v[26:27], v234 offset:12840
    v_mfma_f32_16x16x32_bf16 v[172:175], v[36:39], v[4:7], v[172:175]
    s_waitcnt lgkmcnt(13)
    ds_read_b64_tr_b16 v[28:29], v234 offset:10296
    ds_read_b64_tr_b16 v[30:31], v234 offset:12856
    v_mfma_f32_16x16x32_bf16 v[176:179], v[40:43], v[4:7], v[176:179]
    s_waitcnt lgkmcnt(13)
    ds_read_b32 v215, v240
    ds_read_b64_tr_b16 v[32:33], v236 offset:10272
    ds_read_b64_tr_b16 v[34:35], v236 offset:12832
    v_mfma_f32_16x16x32_bf16 v[180:183], v[44:47], v[4:7], v[180:183]
    s_waitcnt lgkmcnt(13)
    ds_read_b128 v[12:15], v233 offset:8192
    ds_read_b64_tr_b16 v[36:37], v234 offset:15360
    ds_read_b64_tr_b16 v[38:39], v234 offset:17920
    v_mfma_f32_16x16x32_bf16 v[184:187], v[48:51], v[4:7], v[184:187]
    s_waitcnt lgkmcnt(13)
    ds_read_b64_tr_b16 v[40:41], v234 offset:15376
    ds_read_b64_tr_b16 v[42:43], v234 offset:17936
    v_mfma_f32_16x16x32_bf16 v[188:191], v[52:55], v[4:7], v[188:191]
    s_waitcnt lgkmcnt(13)
q_pad2:
    s_cmp_eq_u32 s37, 2
    s_cbranch_scc1 a_back_q2
    ds_read_b64_tr_b16 v[44:45], v234 offset:15400
    ds_read_b64_tr_b16 v[46:47], v234 offset:17960
    v_mfma_f32_16x16x32_bf16 v[172:175], v[16:19], v[8:11], v[172:175]
    s_waitcnt lgkmcnt(13)
    ds_read_b64_tr_b16 v[48:49], v234 offset:15416
    ds_read_b64_tr_b16 v[50:51], v234 offset:17976
    v_mfma_f32_16x16x32_bf16 v[176:179], v[20:23], v[8:11], v[176:179]
    s_waitcnt lgkmcnt(13)
    ds_read_b64_tr_b16 v[52:53], v236 offset:15392
    ds_read_b64_tr_b16 v[54:55], v236 offset:17952
    s_waitcnt lgkmcnt(13)
    v_cmp_gt_u32 vcc, 2, v215
    v_mfma_f32_16x16x32_bf16 v[180:183], v[24:27], v[8:11], v[180:183]
    s_mov_b64 exec, s[38:39]
    ds_add_u32 v240, v211 offset:16
    s_mov_b64 exec, -1
    s_and_b32 s40, vcc_lo, 12
    s_cbranch_scc1 q_w4
q_r4:
    ds_read_b128 v[0:3], v232 offset:16384
    ds_read_b64_tr_b16 v[16:17], v234 offset:20480
    ds_read_b64_tr_b16 v[18:19], v234 offset:23040
    v_mfma_f32_16x16x32_bf16 v[184:187], v[28:31], v[8:11], v[184:187]
    s_waitcnt lgkmcnt(13)
    ds_read_b64_tr_b16 v[20:21], v234 offset:20496
    ds_read_b64_tr_b16 v[22:23], v234 offset:23056
    v_mfma_f32_16x16x32_bf16 v[188:191], v[32:35], v[8:11], v[188:191]
    s_waitcnt lgkmcnt(13)
    ds_read_b64_tr_b16 v[24:25], v234 offset:20520
    ds_read_b64_tr_b16 v[26:27], v234 offset:23080
    v_mfma_f32_16x16x32_bf16 v[172:175], v[36:39], v[12:15], v[172:175]
    s_waitcnt lgkmcnt(13)
    ds_read_b64_tr_b16 v[28:29], v234 offset:20536
    ds_read_b64_tr_b16 v[30:31], v234 offset:23096
    v_mfma_f32_16x16x32_bf16 v[176:179], v[40:43], v[12:15], v[176:179]
    s_waitcnt lgkmcnt(13)
    ds_read_b64_tr_b16 v[32:33], v236 offset:20512
    ds_read_b64_tr_b16 v[34:35], v236 offset:23072
    v_mfma_f32_16x16x32_bf16 v[180:183], v[44:47], v[12:15], v[180:183]
    s_waitcnt lgkmcnt(13)
    ds_read_b128 v[4:7], v233 offset:16384
    ds_read_b64_tr_b16 v[36:37], v234 offset:25600
    ds_read_b64_tr_b16 v[38:39], v234 offset:28160
    v_mfma_f32_16x16x32_bf16 v[184:187], v[48:51], v[12:15], v[184:187]
    s_waitcnt lgkmcnt(13)
    ds_read_b64_tr_b16 v[40:41], v234 offset:25616
    ds_read_b64_tr_b16 v[42:43], v234 offset:28176
    v_mfma_f32_16x16x32_bf16 v[188:191], v[52:55], v[12:15], v[188:191]
    s_waitcnt lgkmcnt(13)
q_pad3:
    s_cmp_eq_u32 s37, 2
    s_cbranch_scc1 a_back_q3
    ds_read_b64_tr_b16 v[44:45], v234 offset:25640
    ds_read_b64_tr_b16 v[46:47], v234 offset:28200
    v_mfma_f32_16x16x32_bf16 v[172:175], v[16:19], v[0:3], v[172:175]
    s_waitcnt lgkmcnt(13)
    ds_read_b64_tr_b16 v[48:49], v234 offset:25656
    ds_read_b64_tr_b16 v[50:51], v234 offset:28216
    v_mfma_f32_16x16x32_bf16 v[176:179], v[20:23], v[0:3], v[176:179]
    s_waitcnt lgkmcnt(13)
    ds_read_b64_tr_b16 v[52:53], v236 offset:25632
    ds_read_b64_tr_b16 v[54:55], v236 offset:28192
    v_mfma_f32_16x16x32_bf16 v[180:183], v[24:27], v[0:3], v[180:183]
    s_waitcnt lgkmcnt(13)
    ds_read_b128 v[8:11], v232 offset:24576
    ds_read_b64_tr_b16 v[16:17], v234 offset:30720
    ds_read_b64_tr_b16 v[18:19], v234 offset:33280
    v_mfma_f32_16x16x32_bf16 v[184:187], v[28:31], v[0:3], v[184:187]
    s_waitcnt lgkmcnt(13)
    ds_read_b64_tr_b16 v[20:21], v234 offset:30736
    ds_read_b64_tr_b16 v[22:23], v234 offset:33296
    v_mfma_f32_16x16x32_bf16 v[188:191], v[32:35], v[0:3], v[188:191]
    s_waitcnt lgkmcnt(13)
    ds_read_b64_tr_b16 v[24:25], v234 offset:30760
    ds_read_b64_tr_b16 v[26:27], v234 offset:33320
    v_mfma_f32_16x16x32_bf16 v[172:175], v[36:39], v[4:7], v[172:175]
    s_waitcnt lgkmcnt(13)
    ds_read_b64_tr_b16 v[28:29], v234 offset:30776
    ds_read_b64_tr_b16 v[30:31], v234 offset:33336
    v_mfma_f32_16x16x32_bf16 v[176:179], v[40:43], v[4:7], v[176:179]
    s_waitcnt lgkmcnt(13)
    ds_read_b32 v215, v240
    ds_read_b64_tr_b16 v[32:33], v236 offset:30752
    ds_read_b64_tr_b16 v[34:35], v236 offset:33312
    v_mfma_f32_16x16x32_bf16 v[180:183], v[44:47], v[4:7], v[180:183]
    s_waitcnt lgkmcnt(13)
    ds_read_b128 v[12:15], v233 offset:24576
    ds_read_b64_tr_b16 v[36:37], v234 offset:35840
    ds_read_b64_tr_b16 v[38:39], v234 offset:38400
    v_mfma_f32_16x16x32_bf16 v[184:187], v[48:51], v[4:7], v[184:187]
    s_waitcnt lgkmcnt(13)
    ds_read_b64_tr_b16 v[40:41], v234 offset:35856
    ds_read_b64_tr_b16 v[42:43], v234 offset:38416
    v_mfma_f32_16x16x32_bf16 v[188:191], v[52:55], v[4:7], v[188:191]
    s_waitcnt lgkmcnt(13)
q_pad4:
    s_cmp_eq_u32 s37, 2
    s_cbranch_scc1 a_back_q4
    ds_read_b64_tr_b16 v[44:45], v234 offset:35880
    ds_read_b64_tr_b16 v[46:47], v234 offset:38440
    v_mfma_f32_16x16x32_bf16 v[172:175], v[16:19], v[8:11], v[172:175]
    s_waitcnt lgkmcnt(13)
    ds_read_b64_tr_b16 v[48:49], v234 offset:35896
    ds_read_b64_tr_b16 v[50:51], v234 offset:38456
    v_mfma_f32_16x16x32_bf16 v[176:179], v[20:23], v[8:11], v[176:179]
    s_waitcnt lgkmcnt(13)
    ds_read_b64_tr_b16 v[52:53], v236 offset:35872
    ds_read_b64_tr_b16 v[54:55], v236 offset:38432
    s_waitcnt lgkmcnt(13)
    v_cmp_gt_u32 vcc, 3, v215
    v_mfma_f32_16x16x32_bf16 v[180:183], v[24:27], v[8:11], v[180:183]
    s_mov_b64 exec, s[38:39]
    ds_add_u32 v240, v211 offset:16
    s_mov_b64 exec, -1
    s_and_b32 s40, vcc_lo, 12
    s_cbranch_scc1 q_w8
q_r8:
    ds_read_b128 v[0:3], v232 offset:32768
    ds_read_b64_tr_b16 v[16:17], v235 offset:0
    ds_read_b64_tr_b16 v[18:19], v235 offset:2560
    v_mfma_f32_16x16x32_bf16 v[184:187], v[28:31], v[8:11], v[184:187]
    s_waitcnt lgkmcnt(13)
    ds_read_b64_tr_b16 v[20:21], v235 offset:16
    ds_read_b64_tr_b16 v[22:23], v235 offset:2576
    v_mfma_f32_16x16x32_bf16 v[188:191], v[32:35], v[8:11], v[188:191]
    s_waitcnt lgkmcnt(13)
    ds_read_b64_tr_b16 v[24:25], v235 offset:40
    ds_read_b64_tr_b16 v[26:27], v235 offset:2600
    v_mfma_f32_16x16x32_bf16 v[172:175], v[36:39], v[12:15], v[172:175]
    s_waitcnt lgkmcnt(13)
    ds_read_b64_tr_b16 v[28:29], v235 offset:56
    ds_read_b64_tr_b16 v[30:31], v235 offset:2616
    v_mfma_f32_16x16x32_bf16 v[176:179], v[40:43], v[12:15], v[176:179]
    s_waitcnt lgkmcnt(13)
    ds_read_b64_tr_b16 v[32:33], v237 offset:32
    ds_read_b64_tr_b16 v[34:35], v237 offset:2592
    v_mfma_f32_16x16x32_bf16 v[180:183], v[44:47], v[12:15], v[180:183]
    s_waitcnt lgkmcnt(13)
    ds_read_b128 v[4:7], v233 offset:32768
    ds_read_b64_tr_b16 v[36:37], v235 offset:5120
    ds_read_b64_tr_b16 v[38:39], v235 offset:7680
    v_mfma_f32_16x16x32_bf16 v[184:187], v[48:51], v[12:15], v[184:187]
    s_waitcnt lgkmcnt(13)
    ds_read_b64_tr_b16 v[40:41], v235 offset:5136
    ds_read_b64_tr_b16 v[42:43], v235 offset:7696
    v_mfma_f32_16x16x32_bf16 v[188:191], v[52:55], v[12:15], v[188:191]
    s_waitcnt lgkmcnt(13)
q_pad5:
    s_cmp_eq_u32 s37, 2
    s_cbranch_scc1 a_back_q5
    ds_read_b64_tr_b16 v[44:45], v235 offset:5160
    ds_read_b64_tr_b16 v[46:47], v235 offset:7720
    v_mfma_f32_16x16x32_bf16 v[172:175], v[16:19], v[0:3], v[172:175]
    s_waitcnt lgkmcnt(13)
    ds_read_b64_tr_b16 v[48:49], v235 offset:5176
    ds_read_b64_tr_b16 v[50:51], v235 offset:7736
    v_mfma_f32_16x16x32_bf16 v[176:179], v[20:23], v[0:3], v[176:179]
    s_waitcnt lgkmcnt(13)
    ds_read_b64_tr_b16 v[52:53], v237 offset:5152
    ds_read_b64_tr_b16 v[54:55], v237 offset:7712
    v_mfma_f32_16x16x32_bf16 v[180:183], v[24:27], v[0:3], v[180:183]
    s_waitcnt lgkmcnt(13)
    s_mov_b64 exec, s[38:39]
    ds_add_u32 v240, v211 offset:16
    s_mov_b64 exec, -1
    ds_read_b128 v[8:11], v232 offset:40960
    ds_read_b64_tr_b16 v[16:17], v235 offset:10240
    ds_read_b64_tr_b16 v[18:19], v235 offset:12800
    v_mfma_f32_16x16x32_bf16 v[184:187], v[28:31], v[0:3], v[184:187]
    s_waitcnt lgkmcnt(13)
    ds_read_b64_tr_b16 v[20:21], v235 offset:10256
    ds_read_b64_tr_b16 v[22:23], v235 offset:12816
    v_mfma_f32_16x16x32_bf16 v[188:191], v[32:35], v[0:3], v[188:191]
    s_waitcnt lgkmcnt(13)
    ds_read_b64_tr_b16 v[24:25], v235 offset:10280
    ds_read_b64_tr_b16 v[26:27], v235 offset:12840
    v_mfma_f32_16x16x32_bf16 v[172:175], v[36:39], v[4:7], v[172:175]
    s_waitcnt lgkmcnt(13)
    ds_read_b64_tr_b16 v[28:29], v235 offset:10296
    ds_read_b64_tr_b16 v[30:31], v235 offset:12856
    v_mfma_f32_16x16x32_bf16 v[176:179], v[40:43], v[4:7], v[176:179]
    s_waitcnt lgkmcnt(13)
    ds_read_b32 v215, v240
    ds_read_b64_tr_b16 v[32:33], v237 offset:10272
    ds_read_b64_tr_b16 v[34:35], v237 offset:12832
    v_mfma_f32_16x16x32_bf16 v[180:183], v[44:47], v[4:7], v[180:183]
    s_waitcnt lgkmcnt(13)
    ds_read_b128 v[12:15], v233 offset:40960
    ds_read_b64_tr_b16 v[36:37], v235 offset:15360
    ds_read_b64_tr_b16 v[38:39], v235 offset:17920
    v_mfma_f32_16x16x32_bf16 v[184:187], v[48:51], v[4:7], v[184:187]
    ds_read_b64_tr_b16 v[40:41], v235 offset:15376
    ds_read_b64_tr_b16 v[42:43], v235 offset:17936
    v_mfma_f32_16x16x32_bf16 v[188:191], v[52:55], v[4:7], v[188:191]
    s_waitcnt lgkmcnt(13)
q_pad6:
    s_cmp_eq_u32 s37, 2
    s_cbranch_scc1 a_back_q6
    ds_read_b64_tr_b16 v[44:45], v235 offset:15400
    ds_read_b64_tr_b16 v[46:47], v235 offset:17960
    v_mfma_f32_16x16x32_bf16 v[172:175], v[16:19], v[8:11], v[172:175]
    s_waitcnt lgkmcnt(13)
    ds_read_b64_tr_b16 v[48:49], v235 offset:15416
    ds_read_b64_tr_b16 v[50:51], v235 offset:17976
    v_mfma_f32_16x16x32_bf16 v[176:179], v[20:23], v[8:11], v[176:179]
    s_waitcnt lgkmcnt(13)
    ds_read_b64_tr_b16 v[52:53], v237 offset:15392
    ds_read_b64_tr_b16 v[54:55], v237 offset:17952
    s_waitcnt lgkmcnt(13)
    v_cmp_gt_u32 vcc, 4, v215
    v_mfma_f32_16x16x32_bf16 v[180:183], v[24:27], v[8:11], v[180:183]
    s_and_b32 s40, vcc_lo, 12
    s_cbranch_scc1 q_w12
q_r12:
    ds_read_b128 v[0:3], v232 offset:49152
    ds_read_b64_tr_b16 v[16:17], v234 offset:0
    ds_read_b64_tr_b16 v[18:19], v234 offset:2560
    v_mfma_f32_16x16x32_bf16 v[184:187], v[28:31], v[8:11], v[184:187]
    s_waitcnt lgkmcnt(13)
    ds_read_b64_tr_b16 v[20:21], v234 offset:16
    ds_read_b64_tr_b16 v[22:23], v234 offset:2576
    v_mfma_f32_16x16x32_bf16 v[188:191], v[32:35], v[8:11], v[188:191]
    s_waitcnt lgkmcnt(13)
    ds_read_b64_tr_b16 v[24:25], v234 offset:40
    ds_read_b64_tr_b16 v[26:27], v234 offset:2600
    v_mfma_f32_16x16x32_bf16 v[172:175], v[36:39], v[12:15], v[172:175]
    s_waitcnt lgkmcnt(13)
    ds_read_b64_tr_b16 v[28:29], v234 offset:56
    ds_read_b64_tr_b16 v[30:31], v234 offset:2616
    v_mfma_f32_16x16x32_bf16 v[176:179], v[40:43], v[12:15], v[176:179]
    s_waitcnt lgkmcnt(13)
    ds_read_b32 v215, v240
    ds_read_b64_tr_b16 v[32:33], v236 offset:32
    ds_read_b64_tr_b16 v[34:35], v236 offset:2592
    v_mfma_f32_16x16x32_bf16 v[180:183], v[44:47], v[12:15], v[180:183]
    s_waitcnt lgkmcnt(13)
    ds_read_b128 v[4:7], v233 offset:49152
    ds_read_b64_tr_b16 v[36:37], v234 offset:5120
    ds_read_b64_tr_b16 v[38:39], v234 offset:7680
    v_mfma_f32_16x16x32_bf16 v[184:187], v[48:51], v[12:15], v[184:187]
    s_waitcnt lgkmcnt(13)
    ds_read_b64_tr_b16 v[40:41], v234 offset:5136
    ds_read_b64_tr_b16 v[42:43], v234 offset:7696
    v_mfma_f32_16x16x32_bf16 v[188:191], v[52:55], v[12:15], v[188:191]
    s_waitcnt lgkmcnt(13)
q_pad7:
    s_cmp_eq_u32 s37, 2
    s_cbranch_scc1 a_back_q7
    ds_read_b64_tr_b16 v[44:45], v234 offset:5160
    ds_read_b64_tr_b16 v[46:47], v234 offset:7720
    v_mfma_f32_16x16x32_bf16 v[172:175], v[16:19], v[0:3], v[172:175]
    s_waitcnt lgkmcnt(13)
    ds_read_b64_tr_b16 v[48:49], v234 offset:5176
    ds_read_b64_tr_b16 v[50:51], v234 offset:7736
    v_mfma_f32_16x16x32_bf16 v[176:179], v[20:23], v[0:3], v[176:179]
    s_waitcnt lgkmcnt(13)
    ds_read_b64_tr_b16 v[52:53], v236 offset:5152
    ds_read_b64_tr_b16 v[54:55], v236 offset:7712
    s_waitcnt lgkmcnt(13)
    v_cmp_gt_u32 vcc, 5, v215
    v_mfma_f32_16x16x32_bf16 v[180:183], v[24:27], v[0:3], v[180:183]
    s_and_b32 s40, vcc_lo, 12
    s_cbranch_scc1 q_w14
q_r14:
    ds_read_b128 v[8:11], v232 offset:57344
    ds_read_b64_tr_b16 v[16:17], v234 offset:10240
    ds_read_b64_tr_b16 v[18:19], v234 offset:12800
    v_mfma_f32_16x16x32_bf16 v[184:187], v[28:31], v[0:3], v[184:187]
    s_waitcnt lgkmcnt(13)
    ds_read_b64_tr_b16 v[20:21], v234 offset:10256
    ds_read_b64_tr_b16 v[22:23], v234 offset:12816
    v_mfma_f32_16x16x32_bf16 v[188:191], v[32:35], v[0:3], v[188:191]
    s_waitcnt lgkmcnt(13)
    ds_read_b64_tr_b16 v[24:25], v234 offset:10280
    ds_read_b64_tr_b16 v[26:27], v234 offset:12840
    v_mfma_f32_16x16x32_bf16 v[172:175], v[36:39], v[4:7], v[172:175]
    s_waitcnt lgkmcnt(13)
    ds_read_b64_tr_b16 v[28:29], v234 offset:10296
    ds_read_b64_tr_b16 v[30:31], v234 offset:12856
    v_mfma_f32_16x16x32_bf16 v[176:179], v[40:43], v[4:7], v[176:179]
    s_waitcnt lgkmcnt(13)
    ds_read_b32 v215, v240
    ds_read_b64_tr_b16 v[32:33], v236 offset:10272
    ds_read_b64_tr_b16 v[34:35], v236 offset:12832
    v_mfma_f32_16x16x32_bf16 v[180:183], v[44:47], v[4:7], v[180:183]
    s_waitcnt lgkmcnt(13)
    ds_read_b128 v[12:15], v233 offset:57344
    ds_read_b64_tr_b16 v[36:37], v234 offset:15360
    ds_read_b64_tr_b16 v[38:39], v234 offset:17920
    v_mfma_f32_16x16x32_bf16 v[184:187], v[48:51], v[4:7], v[184:187]
    s_waitcnt lgkmcnt(13)
    ds_read_b64_tr_b16 v[40:41], v234 offset:15376
    ds_read_b64_tr_b16 v[42:43], v234 offset:17936
    v_mfma_f32_16x16x32_bf16 v[188:191], v[52:55], v[4:7], v[188:191]
    s_waitcnt lgkmcnt(13)
q_pad8:
    s_cmp_eq_u32 s37, 2
    s_cbranch_scc1 a_back_q8
    ds_read_b64_tr_b16 v[44:45], v234 offset:15400
    ds_read_b64_tr_b16 v[46:47], v234 offset:17960
    v_mfma_f32_16x16x32_bf16 v[172:175], v[16:19], v[8:11], v[172:175]
    s_waitcnt lgkmcnt(13)
    ds_read_b64_tr_b16 v[48:49], v234 offset:15416
    ds_read_b64_tr_b16 v[50:51], v234 offset:17976
    v_mfma_f32_16x16x32_bf16 v[176:179], v[20:23], v[8:11], v[176:179]
    s_waitcnt lgkmcnt(13)
    ds_read_b64_tr_b16 v[52:53], v236 offset:15392
    ds_read_b64_tr_b16 v[54:55], v236 offset:17952
    s_waitcnt lgkmcnt(13)
    v_cmp_gt_u32 vcc, 6, v215
    v_mfma_f32_16x16x32_bf16 v[180:183], v[24:27], v[8:11], v[180:183]
    s_and_b32 s40, vcc_lo, 12
    s_cbranch_scc1 q_w16
q_r16:
    v_add_u32 v232, 65536, v232
    v_add_u32 v233, 65536, v233
    ds_read_b128 v[0:3], v232 offset:0
    ds_read_b64_tr_b16 v[16:17], v234 offset:20480
    ds_read_b64_tr_b16 v[18:19], v234 offset:23040
    v_mfma_f32_16x16x32_bf16 v[184:187], v[28:31], v[8:11], v[184:187]
    s_waitcnt lgkmcnt(13)
    ds_read_b64_tr_b16 v[20:21], v234 offset:20496
    ds_read_b64_tr_b16 v[22:23], v234 offset:23056
    v_mfma_f32_16x16x32_bf16 v[188:191], v[32:35], v[8:11], v[188:191]
    s_waitcnt lgkmcnt(13)
    ds_read_b64_tr_b16 v[24:25], v234 offset:20520
    ds_read_b64_tr_b16 v[26:27], v234 offset:23080
    v_mfma_f32_16x16x32_bf16 v[172:175], v[36:39], v[12:15], v[172:175]
    s_waitcnt lgkmcnt(13)
    ds_read_b64_tr_b16 v[28:29], v234 offset:20536
    ds_read_b64_tr_b16 v[30:31], v234 offset:23096
    v_mfma_f32_16x16x32_bf16 v[176:179], v[40:43], v[12:15], v[176:179]
    s_waitcnt lgkmcnt(13)
    ds_read_b32 v215, v240
    ds_read_b64_tr_b16 v[32:33], v236 offset:20512
    ds_read_b64_tr_b16 v[34:35], v236 offset:23072
    v_mfma_f32_16x16x32_bf16 v[180:183], v[44:47], v[12:15], v[180:183]
    s_waitcnt lgkmcnt(13)
    ds_read_b128 v[4:7], v233 offset:0
    ds_read_b64_tr_b16 v[36:37], v234 offset:25600
    ds_read_b64_tr_b16 v[38:39], v234 offset:28160
    v_mfma_f32_16x16x32_bf16 v[184:187], v[48:51], v[12:15], v[184:187]
    s_waitcnt lgkmcnt(13)
    ds_read_b64_tr_b16 v[40:41], v234 offset:25616
    ds_read_b64_tr_b16 v[42:43], v234 offset:28176
    v_mfma_f32_16x16x32_bf16 v[188:191], v[52:55], v[12:15], v[188:191]
    s_waitcnt lgkmcnt(13)
q_pad9:
    s_cmp_eq_u32 s37, 2
    s_cbranch_scc1 a_back_q9
    ds_read_b64_tr_b16 v[44:45], v234 offset:25640
    ds_read_b64_tr_b16 v[46:47], v234 offset:28200
    v_mfma_f32_16x16x32_bf16 v[172:175], v[16:19], v[0:3], v[172:175]
    s_waitcnt lgkmcnt(13)
    ds_read_b64_tr_b16 v[48:49], v234 offset:25656
    ds_read_b64_tr_b16 v[50:51], v234 offset:28216
    v_mfma_f32_16x16x32_bf16 v[176:179], v[20:23], v[0:3], v[176:179]
    s_waitcnt lgkmcnt(13)
    ds_read_b64_tr_b16 v[52:53], v236 offset:25632
    ds_read_b64_tr_b16 v[54:55], v236 offset:28192
    s_waitcnt lgkmcnt(13)
    v_cmp_gt_u32 vcc, 7, v215
    v_mfma_f32_16x16x32_bf16 v[180:183], v[24:27], v[0:3], v[180:183]
    s_and_b32 s40, vcc_lo, 12
    s_cbranch_scc1 q_w18
q_r18:
    ds_read_b128 v[8:11], v232 offset:8192
    ds_read_b64_tr_b16 v[16:17], v234 offset:30720
    ds_read_b64_tr_b16 v[18:19], v234 offset:33280
    v_mfma_f32_16x16x32_bf16 v[184:187], v[28:31], v[0:3], v[184:187]
    s_waitcnt lgkmcnt(13)
    ds_read_b64_tr_b16 v[20:21], v234 offset:30736
    ds_read_b64_tr_b16 v[22:23], v234 offset:33296
    v_mfma_f32_16x16x32_bf16 v[188:191], v[32:35], v[0:3], v[188:191]
    s_waitcnt lgkmcnt(13)
    ds_read_b64_tr_b16 v[24:25], v234 offset:30760
    ds_read_b64_tr_b16 v[26:27], v234 offset:33320
    v_mfma_f32_16x16x32_bf16 v[172:175], v[36:39], v[4:7], v[172:175]
    s_waitcnt lgkmcnt(13)
    ds_read_b64_tr_b16 v[28:29], v234 offset:30776
    ds_read_b64_tr_b16 v[30:31], v234 offset:33336
    v_mfma_f32_16x16x32_bf16 v[176:179], v[40:43], v[4:7], v[176:179]
    s_waitcnt lgkmcnt(13)
    ds_read_b64_tr_b16 v[32:33], v236 offset:30752
    ds_read_b64_tr_b16 v[34:35], v236 offset:33312
    v_mfma_f32_16x16x32_bf16 v[180:183], v[44:47], v[4:7], v[180:183]
    s_waitcnt lgkmcnt(13)
    ds_read_b128 v[12:15], v233 offset:8192
    ds_read_b64_tr_b16 v[36:37], v234 offset:35840
    ds_read_b64_tr_b16 v[38:39], v234 offset:38400
    v_mfma_f32_16x16x32_bf16 v[184:187], v[48:51], v[4:7], v[184:187]
    s_waitcnt lgkmcnt(13)
    ds_read_b64_tr_b16 v[40:41], v234 offset:35856
    ds_read_b64_tr_b16 v[42:43], v234 offset:38416
    v_mfma_f32_16x16x32_bf16 v[188:191], v[52:55], v[4:7], v[188:191]
    s_waitcnt lgkmcnt(13)
q_pad10:
    s_cmp_eq_u32 s37, 2
    s_cbranch_scc1 a_back_q10
    ds_read_b64_tr_b16 v[44:45], v234 offset:35880
    ds_read_b64_tr_b16 v[46:47], v234 offset:38440
    v_mfma_f32_16x16x32_bf16 v[172:175], v[16:19], v[8:11], v[172:175]
    s_waitcnt lgkmcnt(13)
    ds_read_b64_tr_b16 v[48:49], v234 offset:35896
    ds_read_b64_tr_b16 v[50:51], v234 offset:38456
    v_mfma_f32_16x16x32_bf16 v[176:179], v[20:23], v[8:11], v[176:179]
    s_waitcnt lgkmcnt(13)
    ds_read_b64_tr_b16 v[52:53], v236 offset:35872
    ds_read_b64_tr_b16 v[54:55], v236 offset:38432
    v_mfma_f32_16x16x32_bf16 v[180:183], v[24:27], v[8:11], v[180:183]
    s_waitcnt lgkmcnt(13)
    v_mfma_f32_16x16x32_bf16 v[184:187], v[28:31], v[8:11], v[184:187]
    s_waitcnt lgkmcnt(11)
    v_mfma_f32_16x16x32_bf16 v[188:191], v[32:35], v[8:11], v[188:191]
    s_waitcnt lgkmcnt(8)
    v_mfma_f32_16x16x32_bf16 v[172:175], v[36:39], v[12:15], v[172:175]
    s_barrier
    ds_read_b128 v[148:151], v169 offset:4608
    ds_read_b128 v[140:143], v169
    ds_read_b128 v[152:155], v138 offset:2048
    ds_read_b128 v[156:159], v138 offset:2368
    ds_read_b128 v[144:147], v169 offset:512
    s_waitcnt lgkmcnt(11)
    v_mfma_f32_16x16x32_bf16 v[176:179], v[40:43], v[12:15], v[176:179]
    s_waitcnt lgkmcnt(9)
    v_mfma_f32_16x16x32_bf16 v[180:183], v[44:47], v[12:15], v[180:183]
    s_waitcnt lgkmcnt(7)
    v_mfma_f32_16x16x32_bf16 v[184:187], v[48:51], v[12:15], v[184:187]
    s_waitcnt lgkmcnt(5)
    v_mfma_f32_16x16x32_bf16 v[188:191], v[52:55], v[12:15], v[188:191]
    v_mov_b32 v208, 0x3f80
    v_mov_b32 v209, 0
    s_setprio 2
    v_cvt_pk_bf16_f32 v128, v172, v173
    v_cvt_pk_bf16_f32 v129, v174, v175
    v_cvt_pk_bf16_f32 v130, v176, v177
    v_cvt_pk_bf16_f32 v131, v178, v179
    v_cvt_pk_bf16_f32 v132, v180, v181
    v_cvt_pk_bf16_f32 v133, v182, v183
    v_cvt_pk_bf16_f32 v136, v188, v189
    v_cvt_pk_bf16_f32 v137, v190, v191
    v_cvt_pk_bf16_f32 v134, v184, v185
    v_cvt_pk_bf16_f32 v135, v186, v187
q_pad11:
    s_cmp_eq_u32 s37, 2
    s_cbranch_scc1 a_back_q11
    s_waitcnt lgkmcnt(4)
    v_mfma_f32_32x32x4_2b_bf16 v[0:31], v[148:149], v[136:137], 0 cbsz:1 abid:0
    s_waitcnt lgkmcnt(3)
    s_nop 15
    s_nop 0
    v_mfma_f32_32x32x16_bf16 v[0:15], v[140:143], v[128:131], v[0:15]
    v_mfma_f32_32x32x16_bf16 v[16:31], v[140:143], v[132:135], v[16:31]
    v_mov_b64 v[34:35], v[208:209]
    v_mov_b64 v[36:37], 0
    s_nop 1
    v_permlane32_swap_b32 v34, v36
    s_nop 1
    v_xor_b32 v36, v34, v208
    s_nop 2
    v_max3_f32 v32, v0, v1, v2
    v_max3_f32 v32, v32, v3, v4
    v_max3_f32 v32, v32, v5, v6
    v_max3_f32 v32, v32, v7, v8
    v_max3_f32 v32, v32, v9, v10
    v_max3_f32 v32, v32, v11, v12
    v_max3_f32 v32, v32, v13, v14
    v_max_f32 v32, v32, v15
    v_max3_f32 v33, v16, v17, v18
    v_max3_f32 v33, v33, v19, v20
    v_max3_f32 v33, v33, v21, v22
    v_max3_f32 v33, v33, v23, v24
    v_max3_f32 v33, v33, v25, v26
    v_max3_f32 v33, v33, v27, v28
    v_max3_f32 v33, v33, v29, v30
    v_max_f32 v33, v33, v31
    s_nop 1
    v_permlane32_swap_b32 v32, v33
    v_max_f32 v32, v32, v33
    v_sub_f32 v32, 0xc2c80000, v32
    v_lshrrev_b32 v32, 16, v32
    v_mov_b32 v33, 0
    s_nop 1
    v_mfma_f32_32x32x8_bf16 v[0:15], v[34:35], v[32:33], v[0:15]
    s_lshl2_add_u32 s40, s7, 112640
    v_mov_b32 v206, -1
    v_mov_b32 v207, s40
    s_nop 3
    v_mfma_f32_32x32x8_bf16 v[16:31], v[36:37], v[32:33], v[16:31]
    s_nop 3
    v_exp_f32 v0, v0
    v_exp_f32 v1, v1
    v_mfma_f32_32x32x4_2b_bf16 v[96:127], v[208:209], v[32:33], 0
.p2align 3
a_in:
    s_waitcnt lgkmcnt(0)
    ds_read_b128 v[160:163], v138 offset:2688
    ds_read_b128 v[164:167], v138 offset:3008
    v_exp_f32 v2, v2
    v_exp_f32 v3, v3
    v_exp_f32 v4, v4
    v_exp_f32 v5, v5
    v_mfma_f32_32x32x4_2b_bf16 v[32:63], v[148:149], v[136:137], v[96:127] cbsz:1 abid:1
    v_exp_f32 v6, v6
    v_exp_f32 v7, v7
    v_exp_f32 v8, v8
    v_exp_f32 v9, v9
    v_exp_f32 v10, v10
    v_exp_f32 v11, v11
    v_exp_f32 v12, v12
    v_exp_f32 v13, v13
    v_smfmac_f32_32x32x32_bf16 v[64:79], v[152:155], v[0:7], v168
    ds_read_b128 v[140:143], v169 offset:1024
    v_exp_f32 v14, v14
    v_exp_f32 v15, v15
    v_exp_f32 v16, v16
    v_exp_f32 v17, v17
    v_smfmac_f32_32x32x32_bf16 v[64:79], v[156:159], v[8:15], v168
    v_exp_f32 v18, v18
    v_exp_f32 v19, v19
    v_exp_f32 v20, v20
    v_exp_f32 v21, v21
    v_mfma_f32_32x32x16_bf16 v[32:47], v[144:147], v[128:131], v[32:47]
    v_exp_f32 v22, v22
    v_exp_f32 v23, v23
    v_exp_f32 v24, v24
    v_mfma_f32_32x32x16_bf16 v[48:63], v[144:147], v[132:135], v[48:63]
    v_exp_f32 v25, v25
    v_exp_f32 v26, v26
    v_exp_f32 v27, v27
    v_exp_f32 v28, v28
    v_smfmac_f32_32x32x32_bf16 v[80:95], v[152:155], v[16:23], v168
    v_exp_f32 v29, v29
    v_exp_f32 v30, v30
    v_exp_f32 v31, v31
    v_exp_f32 v32, v32
    v_exp_f32 v33, v33
    v_smfmac_f32_32x32x32_bf16 v[80:95], v[156:159], v[24:31], v168
    s_waitcnt lgkmcnt(0)
    ds_read_b128 v[152:155], v138 offset:3328
    ds_read_b128 v[156:159], v138 offset:3648
    v_exp_f32 v34, v34
    v_exp_f32 v35, v35
    v_exp_f32 v36, v36
    v_exp_f32 v37, v37
    v_mfma_f32_32x32x4_2b_bf16 v[0:31], v[150:151], v[136:137], v[96:127] cbsz:1 abid:0
    v_exp_f32 v38, v38
    v_exp_f32 v39, v39
    v_exp_f32 v40, v40
    v_exp_f32 v41, v41
    v_exp_f32 v42, v42
    v_exp_f32 v43, v43
    v_exp_f32 v44, v44
    v_exp_f32 v45, v45
    v_smfmac_f32_32x32x32_bf16 v[64:79], v[160:163], v[32:39], v168
    ds_read_b128 v[144:147], v169 offset:1536
    ds_read_b32 v212, v255 offset:16
    v_exp_f32 v46, v46
    v_exp_f32 v47, v47
    v_exp_f32 v48, v48
    v_exp_f32 v49, v49
    v_smfmac_f32_32x32x32_bf16 v[64:79], v[164:167], v[40:47], v168
    s_mov_b32 s41, 10240
    v_exp_f32 v50, v50
    v_exp_f32 v51, v51
    v_exp_f32 v52, v52
    v_exp_f32 v53, v53
    v_mfma_f32_32x32x16_bf16 v[0:15], v[140:143], v[128:131], v[0:15]
    v_exp_f32 v54, v54
    v_exp_f32 v55, v55
    v_exp_f32 v56, v56
    v_mfma_f32_32x32x16_bf16 v[16:31], v[140:143], v[132:135], v[16:31]
    v_exp_f32 v57, v57
    v_exp_f32 v58, v58
    v_exp_f32 v59, v59
    v_exp_f32 v60, v60
    v_smfmac_f32_32x32x32_bf16 v[80:95], v[160:163], v[48:55], v168
    v_exp_f32 v61, v61
    v_exp_f32 v62, v62
    v_exp_f32 v63, v63
    v_exp_f32 v0, v0
    v_exp_f32 v1, v1
    v_smfmac_f32_32x32x32_bf16 v[80:95], v[164:167], v[56:63], v168
    s_waitcnt lgkmcnt(0)
    ds_read_b128 v[160:163], v138 offset:3968
    ds_read_b128 v[164:167], v138 offset:4288
    v_exp_f32 v2, v2
    v_exp_f32 v3, v3
    v_exp_f32 v4, v4
    v_exp_f32 v5, v5
    v_mfma_f32_32x32x4_2b_bf16 v[32:63], v[150:151], v[136:137], v[96:127] cbsz:1 abid:1
    v_exp_f32 v6, v6
    v_exp_f32 v7, v7
    v_exp_f32 v8, v8
    v_exp_f32 v9, v9
    v_exp_f32 v10, v10
    v_exp_f32 v11, v11
    v_exp_f32 v12, v12
    v_exp_f32 v13, v13
    v_mad_i32_i24 v138, v139, s41, v138
    v_smfmac_f32_32x32x32_bf16 v[64:79], v[152:155], v[0:7], v168
    v_cmp_ne_u32 vcc, -1, v212
    s_nop 0
    s_cmp_eq_u64 vcc, 0
    s_cbranch_scc0 a_f1_w
a_f1_r:
    ds_read_b128 v[140:143], v169 offset:10240
    ds_read_b128 v[172:175], v169 offset:14848
    v_exp_f32 v14, v14
    v_exp_f32 v15, v15
    v_exp_f32 v16, v16
    v_exp_f32 v17, v17
    v_smfmac_f32_32x32x32_bf16 v[64:79], v[156:159], v[8:15], v168
    v_exp_f32 v18, v18
    v_exp_f32 v19, v19
    v_exp_f32 v20, v20
    v_exp_f32 v21, v21
    v_mfma_f32_32x32x16_bf16 v[32:47], v[144:147], v[128:131], v[32:47]
    v_exp_f32 v22, v22
    v_exp_f32 v23, v23
    v_exp_f32 v24, v24
    v_mfma_f32_32x32x16_bf16 v[48:63], v[144:147], v[132:135], v[48:63]
    v_exp_f32 v25, v25
    v_exp_f32 v26, v26
    v_exp_f32 v27, v27
    v_exp_f32 v28, v28
    v_smfmac_f32_32x32x32_bf16 v[80:95], v[152:155], v[16:23], v168
    v_exp_f32 v29, v29
    v_exp_f32 v30, v30
    v_exp_f32 v31, v31
    v_exp_f32 v32, v32
    v_exp_f32 v33, v33
    v_smfmac_f32_32x32x32_bf16 v[80:95], v[156:159], v[24:31], v168
    s_waitcnt lgkmcnt(0)
    ds_read_b128 v[152:155], v138 offset:2048
    ds_read_b128 v[156:159], v138 offset:2368
    v_exp_f32 v34, v34
    v_exp_f32 v35, v35
    v_exp_f32 v36, v36
    v_exp_f32 v37, v37
    v_mfma_f32_32x32x4_2b_bf16 v[0:31], v[172:173], v[136:137], v[96:127] cbsz:1 abid:0
    v_exp_f32 v38, v38
    v_exp_f32 v39, v39
    v_exp_f32 v40, v40
    v_exp_f32 v41, v41
    v_exp_f32 v42, v42
    v_exp_f32 v43, v43
    v_exp_f32 v44, v44
    v_exp_f32 v45, v45
    v_smfmac_f32_32x32x32_bf16 v[64:79], v[160:163], v[32:39], v168
    ds_read_b128 v[144:147], v169 offset:10752
    v_exp_f32 v46, v46
    v_exp_f32 v47, v47
    v_exp_f32 v48, v48
    v_exp_f32 v49, v49
    v_smfmac_f32_32x32x32_bf16 v[64:79], v[164:167], v[40:47], v168
    v_exp_f32 v50, v50
    v_exp_f32 v51, v51
    v_exp_f32 v52, v52
    v_exp_f32 v53, v53
    v_mfma_f32_32x32x16_bf16 v[0:15], v[140:143], v[128:131], v[0:15]
    v_exp_f32 v54, v54
    v_exp_f32 v55, v55
    v_exp_f32 v56, v56
    v_mfma_f32_32x32x16_bf16 v[16:31], v[140:143], v[132:135], v[16:31]
    v_exp_f32 v57, v57
    v_exp_f32 v58, v58
    v_exp_f32 v59, v59
    v_exp_f32 v60, v60
    v_smfmac_f32_32x32x32_bf16 v[80:95], v[160:163], v[48:55], v168
    v_exp_f32 v61, v61
    v_exp_f32 v62, v62
    v_exp_f32 v63, v63
    v_exp_f32 v0, v0
    v_exp_f32 v1, v1
    v_smfmac_f32_32x32x32_bf16 v[80:95], v[164:167], v[56:63], v168
    s_waitcnt lgkmcnt(0)
    ds_read_b128 v[160:163], v138 offset:2688
    ds_read_b128 v[164:167], v138 offset:3008
    v_exp_f32 v2, v2
    v_exp_f32 v3, v3
    v_exp_f32 v4, v4
    v_exp_f32 v5, v5
    v_mfma_f32_32x32x4_2b_bf16 v[32:63], v[172:173], v[136:137], v[96:127] cbsz:1 abid:1
    v_exp_f32 v6, v6
    v_exp_f32 v7, v7
    v_exp_f32 v8, v8
    v_exp_f32 v9, v9
    v_exp_f32 v10, v10
    v_exp_f32 v11, v11
    v_exp_f32 v12, v12
    v_exp_f32 v13, v13
    v_smfmac_f32_32x32x32_bf16 v[64:79], v[152:155], v[0:7], v168
    ds_read_b128 v[140:143], v169 offset:11264
    v_exp_f32 v14, v14
    v_exp_f32 v15, v15
    v_exp_f32 v16, v16
    v_exp_f32 v17, v17
    v_smfmac_f32_32x32x32_bf16 v[64:79], v[156:159], v[8:15], v168
    v_exp_f32 v18, v18
    v_exp_f32 v19, v19
    v_exp_f32 v20, v20
    v_exp_f32 v21, v21
    v_mfma_f32_32x32x16_bf16 v[32:47], v[144:147], v[128:131], v[32:47]
    v_exp_f32 v22, v22
    v_exp_f32 v23, v23
    v_exp_f32 v24, v24
    v_mfma_f32_32x32x16_bf16 v[48:63], v[144:147], v[132:135], v[48:63]
    v_exp_f32 v25, v25
    v_exp_f32 v26, v26
    v_exp_f32 v27, v27
    v_exp_f32 v28, v28
    v_smfmac_f32_32x32x32_bf16 v[80:95], v[152:155], v[16:23], v168
    v_exp_f32 v29, v29
    v_exp_f32 v30, v30
    v_exp_f32 v31, v31
    v_exp_f32 v32, v32
    v_exp_f32 v33, v33
    v_smfmac_f32_32x32x32_bf16 v[80:95], v[156:159], v[24:31], v168
    s_waitcnt lgkmcnt(0)
    ds_read_b128 v[152:155], v138 offset:3328
    ds_read_b128 v[156:159], v138 offset:3648
    s_cmp_eq_u32 s37, 1
    s_cbranch_scc1 u_5a
    v_mov_b32 v176, v72
    v_mov_b32 v179, 0
u_5a:
    v_exp_f32 v34, v34
    v_exp_f32 v35, v35
    v_exp_f32 v36, v36
    v_exp_f32 v37, v37
    v_mfma_f32_32x32x4_2b_bf16 v[0:31], v[174:175], v[136:137], v[96:127] cbsz:1 abid:0
    v_exp_f32 v38, v38
    v_exp_f32 v39, v39
    v_exp_f32 v40, v40
    v_exp_f32 v41, v41
    v_exp_f32 v42, v42
    v_exp_f32 v43, v43
    v_exp_f32 v44, v44
    v_exp_f32 v45, v45
    v_smfmac_f32_32x32x32_bf16 v[64:79], v[160:163], v[32:39], v168
    ds_read_b128 v[144:147], v169 offset:11776
    v_exp_f32 v46, v46
    v_exp_f32 v47, v47
    v_exp_f32 v48, v48
    v_exp_f32 v49, v49
    v_smfmac_f32_32x32x32_bf16 v[64:79], v[164:167], v[40:47], v168
    s_mov_b32 s41, 10240
    s_cmp_eq_u32 s37, 1
    s_cbranch_scc1 u_5b
    v_mov_b32 v177, v88
    s_movk_i32 s42, 147
    s_nop 0
    v_permlane32_swap_b32 v176, v177
    v_bfe_u32 v177, v177, 23, 8
    v_med3_u32 v177, v177, 27, s42
    v_sub_u32 v178, 27, v177
    v_sub_u32 v177, 154, v177
    v_cvt_f32_i32 v178, v178
    v_lshlrev_b32 v177, 23, v177
    v_lshrrev_b32 v178, 16, v178
    v_mov_b32 v176, v177
u_5b:
a_pad0:
    s_cmp_eq_u32 s37, 2
    s_cbranch_scc1 a_back0
    v_exp_f32 v50, v50
    v_exp_f32 v51, v51
    v_exp_f32 v52, v52
    v_exp_f32 v53, v53
    v_mfma_f32_32x32x16_bf16 v[0:15], v[140:143], v[128:131], v[0:15]
    v_exp_f32 v54, v54
    v_exp_f32 v55, v55
    v_exp_f32 v56, v56
    v_mfma_f32_32x32x16_bf16 v[16:31], v[140:143], v[132:135], v[16:31]
    v_exp_f32 v57, v57
    v_exp_f32 v58, v58
    v_exp_f32 v59, v59
    v_exp_f32 v60, v60
    v_smfmac_f32_32x32x32_bf16 v[80:95], v[160:163], v[48:55], v168
    v_exp_f32 v61, v61
    v_exp_f32 v62, v62
    v_exp_f32 v63, v63
    s_cmp_eq_u32 s37, 1
    s_cbranch_scc1 u_5c
    v_mfma_f32_32x32x4_2b_bf16 v[96:127], v[208:209], v[178:179], v[96:127]
    v_permlane32_swap_b32 v176, v177
u_5c:
    v_exp_f32 v0, v0
    v_exp_f32 v1, v1
    v_smfmac_f32_32x32x32_bf16 v[80:95], v[164:167], v[56:63], v168
    s_waitcnt lgkmcnt(0)
    ds_read_b128 v[160:163], v138 offset:3968
    ds_read_b128 v[164:167], v138 offset:4288
    v_exp_f32 v2, v2
    v_exp_f32 v3, v3
    v_exp_f32 v4, v4
    v_exp_f32 v5, v5
    v_mfma_f32_32x32x4_2b_bf16 v[32:63], v[174:175], v[136:137], v[96:127] cbsz:1 abid:1
    v_exp_f32 v6, v6
    v_exp_f32 v7, v7
    v_exp_f32 v8, v8
    v_exp_f32 v9, v9
    v_exp_f32 v10, v10
    v_exp_f32 v11, v11
    v_exp_f32 v12, v12
    v_exp_f32 v13, v13
    v_mad_i32_i24 v138, v139, s41, v138
    v_smfmac_f32_32x32x32_bf16 v[64:79], v[152:155], v[0:7], v168
    s_barrier
    ds_read_b128 v[140:143], v169 offset:20480
    ds_read_b128 v[148:151], v169 offset:25088
    v_exp_f32 v14, v14
    v_exp_f32 v15, v15
    v_exp_f32 v16, v16
    v_exp_f32 v17, v17
    v_smfmac_f32_32x32x32_bf16 v[64:79], v[156:159], v[8:15], v168
    v_exp_f32 v18, v18
    v_exp_f32 v19, v19
    v_exp_f32 v20, v20
    v_exp_f32 v21, v21
    v_mfma_f32_32x32x16_bf16 v[32:47], v[144:147], v[128:131], v[32:47]
    v_exp_f32 v22, v22
    v_exp_f32 v23, v23
    v_exp_f32 v24, v24
    v_mfma_f32_32x32x16_bf16 v[48:63], v[144:147], v[132:135], v[48:63]
    v_exp_f32 v25, v25
    v_exp_f32 v26, v26
    v_exp_f32 v27, v27
    v_exp_f32 v28, v28
    v_smfmac_f32_32x32x32_bf16 v[80:95], v[152:155], v[16:23], v168
    v_exp_f32 v29, v29
    v_exp_f32 v30, v30
    v_exp_f32 v31, v31
    v_exp_f32 v32, v32
    v_exp_f32 v33, v33
    v_smfmac_f32_32x32x32_bf16 v[80:95], v[156:159], v[24:31], v168
    s_waitcnt lgkmcnt(0)
    ds_read_b128 v[152:155], v138 offset:2048
    ds_read_b128 v[156:159], v138 offset:2368
    s_cmp_eq_u32 s37, 1
    s_cbranch_scc1 u_7d
    v_pk_mul_f32 v[64:65], v[64:65], v[176:177] op_sel_hi:[1,0]
    v_pk_mul_f32 v[66:67], v[66:67], v[176:177] op_sel_hi:[1,0]
    v_pk_mul_f32 v[68:69], v[68:69], v[176:177] op_sel_hi:[1,0]
    v_pk_mul_f32 v[70:71], v[70:71], v[176:177] op_sel_hi:[1,0]
    v_pk_mul_f32 v[72:73], v[72:73], v[176:177] op_sel_hi:[1,0]
    v_pk_mul_f32 v[74:75], v[74:75], v[176:177] op_sel_hi:[1,0]
u_7d:
    v_exp_f32 v34, v34
    v_exp_f32 v35, v35
    v_exp_f32 v36, v36
    v_exp_f32 v37, v37
    v_mfma_f32_32x32x4_2b_bf16 v[0:31], v[148:149], v[136:137], v[96:127] cbsz:1 abid:0
    v_exp_f32 v38, v38
    v_exp_f32 v39, v39
    v_exp_f32 v40, v40
    v_exp_f32 v41, v41
    v_exp_f32 v42, v42
    v_exp_f32 v43, v43
    v_exp_f32 v44, v44
    v_exp_f32 v45, v45
    v_smfmac_f32_32x32x32_bf16 v[64:79], v[160:163], v[32:39], v168
    ds_read_b128 v[144:147], v169 offset:20992
    v_exp_f32 v46, v46
    v_exp_f32 v47, v47
    v_exp_f32 v48, v48
    v_exp_f32 v49, v49
    v_smfmac_f32_32x32x32_bf16 v[64:79], v[164:167], v[40:47], v168
    s_cmp_eq_u32 s37, 1
    s_cbranch_scc1 u_7e
    v_pk_mul_f32 v[80:81], v[80:81], v[176:177] op_sel:[0,1]
    v_pk_mul_f32 v[82:83], v[82:83], v[176:177] op_sel:[0,1]
    v_pk_mul_f32 v[84:85], v[84:85], v[176:177] op_sel:[0,1]
    v_pk_mul_f32 v[86:87], v[86:87], v[176:177] op_sel:[0,1]
    v_pk_mul_f32 v[88:89], v[88:89], v[176:177] op_sel:[0,1]
    v_pk_mul_f32 v[90:91], v[90:91], v[176:177] op_sel:[0,1]
u_7e:
    v_exp_f32 v50, v50
    v_exp_f32 v51, v51
    v_exp_f32 v52, v52
    v_exp_f32 v53, v53
    v_mfma_f32_32x32x16_bf16 v[0:15], v[140:143], v[128:131], v[0:15]
    v_exp_f32 v54, v54
    v_exp_f32 v55, v55
    v_exp_f32 v56, v56
    v_mfma_f32_32x32x16_bf16 v[16:31], v[140:143], v[132:135], v[16:31]
    v_exp_f32 v57, v57
    v_exp_f32 v58, v58
    v_exp_f32 v59, v59
    v_exp_f32 v60, v60
    v_smfmac_f32_32x32x32_bf16 v[80:95], v[160:163], v[48:55], v168
    v_exp_f32 v61, v61
    v_exp_f32 v62, v62
    v_exp_f32 v63, v63
    v_exp_f32 v0, v0
    v_exp_f32 v1, v1
    v_smfmac_f32_32x32x32_bf16 v[80:95], v[164:167], v[56:63], v168
    s_waitcnt lgkmcnt(0)
    ds_read_b128 v[160:163], v138 offset:2688
    ds_read_b128 v[164:167], v138 offset:3008
    v_exp_f32 v2, v2
    v_exp_f32 v3, v3
    v_exp_f32 v4, v4
    v_exp_f32 v5, v5
    v_mfma_f32_32x32x4_2b_bf16 v[32:63], v[148:149], v[136:137], v[96:127] cbsz:1 abid:1
    v_exp_f32 v6, v6
    v_exp_f32 v7, v7
    v_exp_f32 v8, v8
    v_exp_f32 v9, v9
    v_exp_f32 v10, v10
    v_exp_f32 v11, v11
    v_exp_f32 v12, v12
    v_exp_f32 v13, v13
    v_smfmac_f32_32x32x32_bf16 v[64:79], v[152:155], v[0:7], v168
    ds_read_b128 v[140:143], v169 offset:21504
    v_exp_f32 v14, v14
    v_exp_f32 v15, v15
    v_exp_f32 v16, v16
    v_exp_f32 v17, v17
    v_smfmac_f32_32x32x32_bf16 v[64:79], v[156:159], v[8:15], v168
    v_exp_f32 v18, v18
    v_exp_f32 v19, v19
    v_exp_f32 v20, v20
    v_exp_f32 v21, v21
    v_mfma_f32_32x32x16_bf16 v[32:47], v[144:147], v[128:131], v[32:47]
    v_exp_f32 v22, v22
    v_exp_f32 v23, v23
    v_exp_f32 v24, v24
    v_mfma_f32_32x32x16_bf16 v[48:63], v[144:147], v[132:135], v[48:63]
    v_exp_f32 v25, v25
    v_exp_f32 v26, v26
    v_exp_f32 v27, v27
    v_exp_f32 v28, v28
    v_smfmac_f32_32x32x32_bf16 v[80:95], v[152:155], v[16:23], v168
    v_exp_f32 v29, v29
    v_exp_f32 v30, v30
    v_exp_f32 v31, v31
    v_exp_f32 v32, v32
    v_exp_f32 v33, v33
    v_smfmac_f32_32x32x32_bf16 v[80:95], v[156:159], v[24:31], v168
    s_waitcnt lgkmcnt(0)
    ds_read_b128 v[152:155], v138 offset:3328
    ds_read_b128 v[156:159], v138 offset:3648
    v_exp_f32 v34, v34
    v_exp_f32 v35, v35
    v_exp_f32 v36, v36
    v_exp_f32 v37, v37
    v_mfma_f32_32x32x4_2b_bf16 v[0:31], v[150:151], v[136:137], v[96:127] cbsz:1 abid:0
    v_exp_f32 v38, v38
    v_exp_f32 v39, v39
    v_exp_f32 v40, v40
    v_exp_f32 v41, v41
    v_exp_f32 v42, v42
    v_exp_f32 v43, v43
    v_exp_f32 v44, v44
    v_exp_f32 v45, v45
    v_smfmac_f32_32x32x32_bf16 v[64:79], v[160:163], v[32:39], v168
    ds_read_b128 v[144:147], v169 offset:22016
    v_exp_f32 v46, v46
    v_exp_f32 v47, v47
    v_exp_f32 v48, v48
    v_exp_f32 v49, v49
    v_smfmac_f32_32x32x32_bf16 v[64:79], v[164:167], v[40:47], v168
    s_mov_b32 s41, 10240
    v_exp_f32 v50, v50
    v_exp_f32 v51, v51
    v_exp_f32 v52, v52
    v_exp_f32 v53, v53
    v_mfma_f32_32x32x16_bf16 v[0:15], v[140:143], v[128:131], v[0:15]
    v_exp_f32 v54, v54
    v_exp_f32 v55, v55
    v_exp_f32 v56, v56
    v_mfma_f32_32x32x16_bf16 v[16:31], v[140:143], v[132:135], v[16:31]
    v_exp_f32 v57, v57
    v_exp_f32 v58, v58
    v_exp_f32 v59, v59
    v_exp_f32 v60, v60
    v_smfmac_f32_32x32x32_bf16 v[80:95], v[160:163], v[48:55], v168
    v_exp_f32 v61, v61
    v_exp_f32 v62, v62
    v_exp_f32 v63, v63
    v_exp_f32 v0, v0
    v_exp_f32 v1, v1
    v_smfmac_f32_32x32x32_bf16 v[80:95], v[164:167], v[56:63], v168
    s_waitcnt lgkmcnt(0)
    ds_read_b128 v[160:163], v138 offset:3968
    ds_read_b128 v[164:167], v138 offset:4288
    v_exp_f32 v2, v2
    v_exp_f32 v3, v3
    v_exp_f32 v4, v4
    v_exp_f32 v5, v5
    v_mfma_f32_32x32x4_2b_bf16 v[32:63], v[150:151], v[136:137], v[96:127] cbsz:1 abid:1
    v_exp_f32 v6, v6
    v_exp_f32 v7, v7
    v_exp_f32 v8, v8
    v_exp_f32 v9, v9
    v_exp_f32 v10, v10
    v_exp_f32 v11, v11
    v_exp_f32 v12, v12
    v_exp_f32 v13, v13
    v_mad_i32_i24 v138, v139, s41, v138
    v_smfmac_f32_32x32x32_bf16 v[64:79], v[152:155], v[0:7], v168
    ds_read_b128 v[140:143], v169 offset:30720
    ds_read_b128 v[172:175], v169 offset:35328
    v_exp_f32 v14, v14
    v_exp_f32 v15, v15
    v_exp_f32 v16, v16
    v_exp_f32 v17, v17
    v_smfmac_f32_32x32x32_bf16 v[64:79], v[156:159], v[8:15], v168
    v_exp_f32 v18, v18
    v_exp_f32 v19, v19
    v_exp_f32 v20, v20
    v_exp_f32 v21, v21
    v_mfma_f32_32x32x16_bf16 v[32:47], v[144:147], v[128:131], v[32:47]
    v_exp_f32 v22, v22
    v_exp_f32 v23, v23
    v_exp_f32 v24, v24
    v_mfma_f32_32x32x16_bf16 v[48:63], v[144:147], v[132:135], v[48:63]
    v_exp_f32 v25, v25
    v_exp_f32 v26, v26
    v_exp_f32 v27, v27
    v_exp_f32 v28, v28
    v_smfmac_f32_32x32x32_bf16 v[80:95], v[152:155], v[16:23], v168
    v_exp_f32 v29, v29
    v_exp_f32 v30, v30
    v_exp_f32 v31, v31
    v_exp_f32 v32, v32
    v_exp_f32 v33, v33
    v_smfmac_f32_32x32x32_bf16 v[80:95], v[156:159], v[24:31], v168
    s_waitcnt lgkmcnt(0)
    ds_read_b128 v[152:155], v138 offset:2048
    ds_read_b128 v[156:159], v138 offset:2368
    v_exp_f32 v34, v34
    v_exp_f32 v35, v35
    v_exp_f32 v36, v36
    v_exp_f32 v37, v37
    v_mfma_f32_32x32x4_2b_bf16 v[0:31], v[172:173], v[136:137], v[96:127] cbsz:1 abid:0
    v_exp_f32 v38, v38
    v_exp_f32 v39, v39
    v_exp_f32 v40, v40
    v_exp_f32 v41, v41
    v_exp_f32 v42, v42
    v_exp_f32 v43, v43
    v_exp_f32 v44, v44
    v_exp_f32 v45, v45
    v_smfmac_f32_32x32x32_bf16 v[64:79], v[160:163], v[32:39], v168
    ds_read_b128 v[144:147], v169 offset:31232
    v_exp_f32 v46, v46
    v_exp_f32 v47, v47
    v_exp_f32 v48, v48
    v_exp_f32 v49, v49
    v_smfmac_f32_32x32x32_bf16 v[64:79], v[164:167], v[40:47], v168
    v_exp_f32 v50, v50
    v_exp_f32 v51, v51
    v_exp_f32 v52, v52
    v_exp_f32 v53, v53
    v_mfma_f32_32x32x16_bf16 v[0:15], v[140:143], v[128:131], v[0:15]
    v_exp_f32 v54, v54
    v_exp_f32 v55, v55
    v_exp_f32 v56, v56
    v_mfma_f32_32x32x16_bf16 v[16:31], v[140:143], v[132:135], v[16:31]
    v_exp_f32 v57, v57
    v_exp_f32 v58, v58
    v_exp_f32 v59, v59
    v_exp_f32 v60, v60
    v_smfmac_f32_32x32x32_bf16 v[80:95], v[160:163], v[48:55], v168
    v_exp_f32 v61, v61
    v_exp_f32 v62, v62
    v_exp_f32 v63, v63
    v_exp_f32 v0, v0
    v_exp_f32 v1, v1
    v_smfmac_f32_32x32x32_bf16 v[80:95], v[164:167], v[56:63], v168
    s_waitcnt lgkmcnt(0)
    ds_read_b128 v[160:163], v138 offset:2688
    ds_read_b128 v[164:167], v138 offset:3008
    v_exp_f32 v2, v2
    v_exp_f32 v3, v3
    v_exp_f32 v4, v4
    v_exp_f32 v5, v5
    v_mfma_f32_32x32x4_2b_bf16 v[32:63], v[172:173], v[136:137], v[96:127] cbsz:1 abid:1
    v_exp_f32 v6, v6
    v_exp_f32 v7, v7
    v_exp_f32 v8, v8
    v_exp_f32 v9, v9
    v_exp_f32 v10, v10
    v_exp_f32 v11, v11
    v_exp_f32 v12, v12
    v_exp_f32 v13, v13
    v_smfmac_f32_32x32x32_bf16 v[64:79], v[152:155], v[0:7], v168
    ds_read_b128 v[140:143], v169 offset:31744
    v_exp_f32 v14, v14
    v_exp_f32 v15, v15
    v_exp_f32 v16, v16
    v_exp_f32 v17, v17
    v_smfmac_f32_32x32x32_bf16 v[64:79], v[156:159], v[8:15], v168
    v_exp_f32 v18, v18
    v_exp_f32 v19, v19
    v_exp_f32 v20, v20
    v_exp_f32 v21, v21
    v_mfma_f32_32x32x16_bf16 v[32:47], v[144:147], v[128:131], v[32:47]
    v_exp_f32 v22, v22
    v_exp_f32 v23, v23
    v_exp_f32 v24, v24
    v_mfma_f32_32x32x16_bf16 v[48:63], v[144:147], v[132:135], v[48:63]
    v_exp_f32 v25, v25
    v_exp_f32 v26, v26
    v_exp_f32 v27, v27
    v_exp_f32 v28, v28
    v_smfmac_f32_32x32x32_bf16 v[80:95], v[152:155], v[16:23], v168
    v_exp_f32 v29, v29
    v_exp_f32 v30, v30
    v_exp_f32 v31, v31
    v_exp_f32 v32, v32
    v_exp_f32 v33, v33
    v_smfmac_f32_32x32x32_bf16 v[80:95], v[156:159], v[24:31], v168
    s_waitcnt lgkmcnt(0)
    ds_read_b128 v[152:155], v138 offset:3328
    ds_read_b128 v[156:159], v138 offset:3648
    v_exp_f32 v34, v34
    v_exp_f32 v35, v35
    v_exp_f32 v36, v36
    v_exp_f32 v37, v37
    v_mfma_f32_32x32x4_2b_bf16 v[0:31], v[174:175], v[136:137], v[96:127] cbsz:1 abid:0
    v_exp_f32 v38, v38
    v_exp_f32 v39, v39
    v_exp_f32 v40, v40
    v_exp_f32 v41, v41
    v_exp_f32 v42, v42
    v_exp_f32 v43, v43
    v_exp_f32 v44, v44
    v_exp_f32 v45, v45
    v_smfmac_f32_32x32x32_bf16 v[64:79], v[160:163], v[32:39], v168
    ds_read_b128 v[144:147], v169 offset:32256
    v_exp_f32 v46, v46
    v_exp_f32 v47, v47
    v_exp_f32 v48, v48
    v_exp_f32 v49, v49
    v_smfmac_f32_32x32x32_bf16 v[64:79], v[164:167], v[40:47], v168
    s_mov_b32 s41, 10240
    v_exp_f32 v50, v50
    v_exp_f32 v51, v51
    v_exp_f32 v52, v52
    v_exp_f32 v53, v53
    v_mfma_f32_32x32x16_bf16 v[0:15], v[140:143], v[128:131], v[0:15]
    v_exp_f32 v54, v54
    v_exp_f32 v55, v55
    v_exp_f32 v56, v56
    v_mfma_f32_32x32x16_bf16 v[16:31], v[140:143], v[132:135], v[16:31]
    v_exp_f32 v57, v57
    v_exp_f32 v58, v58
    v_exp_f32 v59, v59
    v_exp_f32 v60, v60
    v_smfmac_f32_32x32x32_bf16 v[80:95], v[160:163], v[48:55], v168
    v_exp_f32 v61, v61
    v_exp_f32 v62, v62
    v_exp_f32 v63, v63
    v_exp_f32 v0, v0
    v_exp_f32 v1, v1
    v_smfmac_f32_32x32x32_bf16 v[80:95], v[164:167], v[56:63], v168
    s_waitcnt lgkmcnt(0)
    ds_read_b128 v[160:163], v138 offset:3968
    ds_read_b128 v[164:167], v138 offset:4288
    v_exp_f32 v2, v2
    v_exp_f32 v3, v3
    v_exp_f32 v4, v4
    v_exp_f32 v5, v5
    v_mfma_f32_32x32x4_2b_bf16 v[32:63], v[174:175], v[136:137], v[96:127] cbsz:1 abid:1
    v_exp_f32 v6, v6
    v_exp_f32 v7, v7
    v_exp_f32 v8, v8
    v_exp_f32 v9, v9
    v_exp_f32 v10, v10
    v_exp_f32 v11, v11
    v_exp_f32 v12, v12
    v_exp_f32 v13, v13
    v_mad_i32_i24 v138, v139, s41, v138
    v_smfmac_f32_32x32x32_bf16 v[64:79], v[152:155], v[0:7], v168
    ds_read_b128 v[140:143], v169 offset:40960
    ds_read_b128 v[148:151], v169 offset:45568
    v_exp_f32 v14, v14
    v_exp_f32 v15, v15
    v_exp_f32 v16, v16
    v_exp_f32 v17, v17
    v_smfmac_f32_32x32x32_bf16 v[64:79], v[156:159], v[8:15], v168
    v_exp_f32 v18, v18
    v_exp_f32 v19, v19
    v_exp_f32 v20, v20
    v_exp_f32 v21, v21
    v_mfma_f32_32x32x16_bf16 v[32:47], v[144:147], v[128:131], v[32:47]
    v_exp_f32 v22, v22
    v_exp_f32 v23, v23
    v_exp_f32 v24, v24
    v_mfma_f32_32x32x16_bf16 v[48:63], v[144:147], v[132:135], v[48:63]
    v_exp_f32 v25, v25
    v_exp_f32 v26, v26
    v_exp_f32 v27, v27
    v_exp_f32 v28, v28
    v_smfmac_f32_32x32x32_bf16 v[80:95], v[152:155], v[16:23], v168
    v_exp_f32 v29, v29
    v_exp_f32 v30, v30
    v_exp_f32 v31, v31
    v_exp_f32 v32, v32
    v_exp_f32 v33, v33
    v_smfmac_f32_32x32x32_bf16 v[80:95], v[156:159], v[24:31], v168
    s_waitcnt lgkmcnt(0)
    ds_read_b128 v[152:155], v138 offset:2048
    ds_read_b128 v[156:159], v138 offset:2368
    v_exp_f32 v34, v34
    v_exp_f32 v35, v35
    v_exp_f32 v36, v36
    v_exp_f32 v37, v37
    v_mfma_f32_32x32x4_2b_bf16 v[0:31], v[148:149], v[136:137], v[96:127] cbsz:1 abid:0
    v_exp_f32 v38, v38
    v_exp_f32 v39, v39
    v_exp_f32 v40, v40
    v_exp_f32 v41, v41
    v_exp_f32 v42, v42
    v_exp_f32 v43, v43
    v_exp_f32 v44, v44
    v_exp_f32 v45, v45
    v_smfmac_f32_32x32x32_bf16 v[64:79], v[160:163], v[32:39], v168
    ds_read_b128 v[144:147], v169 offset:41472
    v_exp_f32 v46, v46
    v_exp_f32 v47, v47
    v_exp_f32 v48, v48
    v_exp_f32 v49, v49
    v_smfmac_f32_32x32x32_bf16 v[64:79], v[164:167], v[40:47], v168
    v_exp_f32 v50, v50
    v_exp_f32 v51, v51
    v_exp_f32 v52, v52
    v_exp_f32 v53, v53
    v_mfma_f32_32x32x16_bf16 v[0:15], v[140:143], v[128:131], v[0:15]
    v_exp_f32 v54, v54
    v_exp_f32 v55, v55
    v_exp_f32 v56, v56
    v_mfma_f32_32x32x16_bf16 v[16:31], v[140:143], v[132:135], v[16:31]
    v_exp_f32 v57, v57
    v_exp_f32 v58, v58
    v_exp_f32 v59, v59
    v_exp_f32 v60, v60
    v_smfmac_f32_32x32x32_bf16 v[80:95], v[160:163], v[48:55], v168
    v_exp_f32 v61, v61
    v_exp_f32 v62, v62
    v_exp_f32 v63, v63
    v_exp_f32 v0, v0
    v_exp_f32 v1, v1
    v_smfmac_f32_32x32x32_bf16 v[80:95], v[164:167], v[56:63], v168
    s_waitcnt lgkmcnt(0)
    ds_read_b128 v[160:163], v138 offset:2688
    ds_read_b128 v[164:167], v138 offset:3008
    v_exp_f32 v2, v2
    v_exp_f32 v3, v3
    v_exp_f32 v4, v4
    v_exp_f32 v5, v5
    v_mfma_f32_32x32x4_2b_bf16 v[32:63], v[148:149], v[136:137], v[96:127] cbsz:1 abid:1
    v_exp_f32 v6, v6
    v_exp_f32 v7, v7
    v_exp_f32 v8, v8
    v_exp_f32 v9, v9
    v_exp_f32 v10, v10
    v_exp_f32 v11, v11
    v_exp_f32 v12, v12
    v_exp_f32 v13, v13
    v_smfmac_f32_32x32x32_bf16 v[64:79], v[152:155], v[0:7], v168
    ds_read_b128 v[140:143], v169 offset:41984
    v_exp_f32 v14, v14
    v_exp_f32 v15, v15
    v_exp_f32 v16, v16
    v_exp_f32 v17, v17
    v_smfmac_f32_32x32x32_bf16 v[64:79], v[156:159], v[8:15], v168
    v_exp_f32 v18, v18
    v_exp_f32 v19, v19
    v_exp_f32 v20, v20
    v_exp_f32 v21, v21
    v_mfma_f32_32x32x16_bf16 v[32:47], v[144:147], v[128:131], v[32:47]
    v_exp_f32 v22, v22
    v_exp_f32 v23, v23
    v_exp_f32 v24, v24
    v_mfma_f32_32x32x16_bf16 v[48:63], v[144:147], v[132:135], v[48:63]
    v_exp_f32 v25, v25
    v_exp_f32 v26, v26
    v_exp_f32 v27, v27
    v_exp_f32 v28, v28
    v_smfmac_f32_32x32x32_bf16 v[80:95], v[152:155], v[16:23], v168
    v_exp_f32 v29, v29
    v_exp_f32 v30, v30
    v_exp_f32 v31, v31
    v_exp_f32 v32, v32
    v_exp_f32 v33, v33
    v_smfmac_f32_32x32x32_bf16 v[80:95], v[156:159], v[24:31], v168
    s_waitcnt lgkmcnt(0)
    ds_read_b128 v[152:155], v138 offset:3328
    ds_read_b128 v[156:159], v138 offset:3648
    v_exp_f32 v34, v34
    v_exp_f32 v35, v35
    v_exp_f32 v36, v36
    v_exp_f32 v37, v37
    v_mfma_f32_32x32x4_2b_bf16 v[0:31], v[150:151], v[136:137], v[96:127] cbsz:1 abid:0
    v_exp_f32 v38, v38
    v_exp_f32 v39, v39
    v_exp_f32 v40, v40
    v_exp_f32 v41, v41
    v_exp_f32 v42, v42
    v_exp_f32 v43, v43
    v_exp_f32 v44, v44
    v_exp_f32 v45, v45
    v_smfmac_f32_32x32x32_bf16 v[64:79], v[160:163], v[32:39], v168
    ds_read_b128 v[144:147], v169 offset:42496
    v_exp_f32 v46, v46
    v_exp_f32 v47, v47
    v_exp_f32 v48, v48
    v_exp_f32 v49, v49
    v_smfmac_f32_32x32x32_bf16 v[64:79], v[164:167], v[40:47], v168
    s_mov_b32 s41, 10240
    v_exp_f32 v50, v50
    v_exp_f32 v51, v51
    v_exp_f32 v52, v52
    v_exp_f32 v53, v53
    v_mfma_f32_32x32x16_bf16 v[0:15], v[140:143], v[128:131], v[0:15]
    v_exp_f32 v54, v54
    v_exp_f32 v55, v55
    v_exp_f32 v56, v56
    v_mfma_f32_32x32x16_bf16 v[16:31], v[140:143], v[132:135], v[16:31]
    v_exp_f32 v57, v57
    v_exp_f32 v58, v58
    v_exp_f32 v59, v59
    v_exp_f32 v60, v60
    v_smfmac_f32_32x32x32_bf16 v[80:95], v[160:163], v[48:55], v168
    v_exp_f32 v61, v61
    v_exp_f32 v62, v62
    v_exp_f32 v63, v63
    v_exp_f32 v0, v0
    v_exp_f32 v1, v1
    v_smfmac_f32_32x32x32_bf16 v[80:95], v[164:167], v[56:63], v168
    s_waitcnt lgkmcnt(0)
    ds_read_b128 v[160:163], v138 offset:3968
    ds_read_b128 v[164:167], v138 offset:4288
    v_exp_f32 v2, v2
    v_exp_f32 v3, v3
    v_exp_f32 v4, v4
    v_exp_f32 v5, v5
    v_mfma_f32_32x32x4_2b_bf16 v[32:63], v[150:151], v[136:137], v[96:127] cbsz:1 abid:1
    v_exp_f32 v6, v6
    v_exp_f32 v7, v7
    v_exp_f32 v8, v8
    v_exp_f32 v9, v9
    v_exp_f32 v10, v10
    v_exp_f32 v11, v11
    v_exp_f32 v12, v12
    v_exp_f32 v13, v13
    v_mad_i32_i24 v138, v139, s41, v138
    v_smfmac_f32_32x32x32_bf16 v[64:79], v[152:155], v[0:7], v168
    ds_read_b128 v[140:143], v169 offset:51200
    ds_read_b128 v[172:175], v169 offset:55808
    v_exp_f32 v14, v14
    v_exp_f32 v15, v15
    v_exp_f32 v16, v16
    v_exp_f32 v17, v17
    v_smfmac_f32_32x32x32_bf16 v[64:79], v[156:159], v[8:15], v168
    v_exp_f32 v18, v18
    v_exp_f32 v19, v19
    v_exp_f32 v20, v20
    v_exp_f32 v21, v21
    v_mfma_f32_32x32x16_bf16 v[32:47], v[144:147], v[128:131], v[32:47]
    v_exp_f32 v22, v22
    v_exp_f32 v23, v23
    v_exp_f32 v24, v24
    v_mfma_f32_32x32x16_bf16 v[48:63], v[144:147], v[132:135], v[48:63]
    v_exp_f32 v25, v25
    v_exp_f32 v26, v26
    v_exp_f32 v27, v27
    v_exp_f32 v28, v28
    v_smfmac_f32_32x32x32_bf16 v[80:95], v[152:155], v[16:23], v168
    v_exp_f32 v29, v29
    v_exp_f32 v30, v30
    v_exp_f32 v31, v31
    v_exp_f32 v32, v32
    v_exp_f32 v33, v33
    v_smfmac_f32_32x32x32_bf16 v[80:95], v[156:159], v[24:31], v168
    s_waitcnt lgkmcnt(0)
    ds_read_b128 v[152:155], v138 offset:2048
    ds_read_b128 v[156:159], v138 offset:2368
    v_exp_f32 v34, v34
    v_exp_f32 v35, v35
    v_exp_f32 v36, v36
    v_exp_f32 v37, v37
    v_mfma_f32_32x32x4_2b_bf16 v[0:31], v[172:173], v[136:137], v[96:127] cbsz:1 abid:0
    v_exp_f32 v38, v38
    v_exp_f32 v39, v39
    v_exp_f32 v40, v40
    v_exp_f32 v41, v41
    v_exp_f32 v42, v42
    v_exp_f32 v43, v43
    v_exp_f32 v44, v44
    v_exp_f32 v45, v45
    v_smfmac_f32_32x32x32_bf16 v[64:79], v[160:163], v[32:39], v168
    ds_read_b128 v[144:147], v169 offset:51712
    v_exp_f32 v46, v46
    v_exp_f32 v47, v47
    v_exp_f32 v48, v48
    v_exp_f32 v49, v49
    v_smfmac_f32_32x32x32_bf16 v[64:79], v[164:167], v[40:47], v168
    v_exp_f32 v50, v50
    v_exp_f32 v51, v51
    v_exp_f32 v52, v52
    v_exp_f32 v53, v53
    v_mfma_f32_32x32x16_bf16 v[0:15], v[140:143], v[128:131], v[0:15]
    v_exp_f32 v54, v54
    v_exp_f32 v55, v55
    v_exp_f32 v56, v56
    v_mfma_f32_32x32x16_bf16 v[16:31], v[140:143], v[132:135], v[16:31]
    v_exp_f32 v57, v57
    v_exp_f32 v58, v58
    v_exp_f32 v59, v59
    v_exp_f32 v60, v60
    v_smfmac_f32_32x32x32_bf16 v[80:95], v[160:163], v[48:55], v168
    v_exp_f32 v61, v61
    v_exp_f32 v62, v62
    v_exp_f32 v63, v63
    v_exp_f32 v0, v0
    v_exp_f32 v1, v1
    v_smfmac_f32_32x32x32_bf16 v[80:95], v[164:167], v[56:63], v168
    s_waitcnt lgkmcnt(0)
    ds_read_b128 v[160:163], v138 offset:2688
    ds_read_b128 v[164:167], v138 offset:3008
    v_exp_f32 v2, v2
    v_exp_f32 v3, v3
    v_exp_f32 v4, v4
    v_exp_f32 v5, v5
    v_mfma_f32_32x32x4_2b_bf16 v[32:63], v[172:173], v[136:137], v[96:127] cbsz:1 abid:1
    v_exp_f32 v6, v6
    v_exp_f32 v7, v7
    v_exp_f32 v8, v8
    v_exp_f32 v9, v9
    v_exp_f32 v10, v10
    v_exp_f32 v11, v11
    v_exp_f32 v12, v12
    v_exp_f32 v13, v13
    v_smfmac_f32_32x32x32_bf16 v[64:79], v[152:155], v[0:7], v168
    ds_read_b128 v[140:143], v169 offset:52224
    v_exp_f32 v14, v14
    v_exp_f32 v15, v15
    v_exp_f32 v16, v16
    v_exp_f32 v17, v17
    v_smfmac_f32_32x32x32_bf16 v[64:79], v[156:159], v[8:15], v168
    v_exp_f32 v18, v18
    v_exp_f32 v19, v19
    v_exp_f32 v20, v20
    v_exp_f32 v21, v21
    v_mfma_f32_32x32x16_bf16 v[32:47], v[144:147], v[128:131], v[32:47]
    v_exp_f32 v22, v22
    v_exp_f32 v23, v23
    v_exp_f32 v24, v24
    v_mfma_f32_32x32x16_bf16 v[48:63], v[144:147], v[132:135], v[48:63]
    v_exp_f32 v25, v25
    v_exp_f32 v26, v26
    v_exp_f32 v27, v27
    v_exp_f32 v28, v28
    v_smfmac_f32_32x32x32_bf16 v[80:95], v[152:155], v[16:23], v168
    v_exp_f32 v29, v29
    v_exp_f32 v30, v30
    v_exp_f32 v31, v31
    v_exp_f32 v32, v32
    v_exp_f32 v33, v33
    v_smfmac_f32_32x32x32_bf16 v[80:95], v[156:159], v[24:31], v168
    s_waitcnt lgkmcnt(0)
    ds_read_b128 v[152:155], v138 offset:3328
    ds_read_b128 v[156:159], v138 offset:3648
    v_exp_f32 v34, v34
    v_exp_f32 v35, v35
    v_exp_f32 v36, v36
    v_exp_f32 v37, v37
    v_mfma_f32_32x32x4_2b_bf16 v[0:31], v[174:175], v[136:137], v[96:127] cbsz:1 abid:0
    v_exp_f32 v38, v38
    v_exp_f32 v39, v39
    v_exp_f32 v40, v40
    v_exp_f32 v41, v41
    v_exp_f32 v42, v42
    v_exp_f32 v43, v43
    v_exp_f32 v44, v44
    v_exp_f32 v45, v45
    v_smfmac_f32_32x32x32_bf16 v[64:79], v[160:163], v[32:39], v168
    ds_read_b128 v[144:147], v169 offset:52736
    v_exp_f32 v46, v46
    v_exp_f32 v47, v47
    v_exp_f32 v48, v48
    v_exp_f32 v49, v49
    v_smfmac_f32_32x32x32_bf16 v[64:79], v[164:167], v[40:47], v168
    s_mov_b32 s41, 10240
    v_exp_f32 v50, v50
    v_exp_f32 v51, v51
    v_exp_f32 v52, v52
    v_exp_f32 v53, v53
    v_mfma_f32_32x32x16_bf16 v[0:15], v[140:143], v[128:131], v[0:15]
    v_exp_f32 v54, v54
    v_exp_f32 v55, v55
    v_exp_f32 v56, v56
    v_mfma_f32_32x32x16_bf16 v[16:31], v[140:143], v[132:135], v[16:31]
    v_exp_f32 v57, v57
    v_exp_f32 v58, v58
    v_exp_f32 v59, v59
    v_exp_f32 v60, v60
    v_smfmac_f32_32x32x32_bf16 v[80:95], v[160:163], v[48:55], v168
    v_exp_f32 v61, v61
    v_exp_f32 v62, v62
    v_exp_f32 v63, v63
    v_exp_f32 v0, v0
    v_exp_f32 v1, v1
    v_smfmac_f32_32x32x32_bf16 v[80:95], v[164:167], v[56:63], v168
    s_waitcnt lgkmcnt(0)
    ds_read_b128 v[160:163], v138 offset:3968
    ds_read_b128 v[164:167], v138 offset:4288
    v_exp_f32 v2, v2
    v_exp_f32 v3, v3
    v_exp_f32 v4, v4
    v_exp_f32 v5, v5
    v_mfma_f32_32x32x4_2b_bf16 v[32:63], v[174:175], v[136:137], v[96:127] cbsz:1 abid:1
    v_exp_f32 v6, v6
    v_exp_f32 v7, v7
    v_exp_f32 v8, v8
    v_exp_f32 v9, v9
    v_exp_f32 v10, v10
    v_exp_f32 v11, v11
    v_exp_f32 v12, v12
    v_exp_f32 v13, v13
    v_mad_i32_i24 v138, v139, s41, v138
    v_add_u32 v169, 61440, v169
    v_smfmac_f32_32x32x32_bf16 v[64:79], v[152:155], v[0:7], v168
    ds_read_b128 v[140:143], v169 offset:0
    ds_read_b128 v[148:151], v169 offset:4608
    v_exp_f32 v14, v14
    v_exp_f32 v15, v15
    v_exp_f32 v16, v16
    v_exp_f32 v17, v17
    v_smfmac_f32_32x32x32_bf16 v[64:79], v[156:159], v[8:15], v168
    v_exp_f32 v18, v18
    v_exp_f32 v19, v19
    v_exp_f32 v20, v20
    v_exp_f32 v21, v21
    v_mfma_f32_32x32x16_bf16 v[32:47], v[144:147], v[128:131], v[32:47]
    v_exp_f32 v22, v22
    v_exp_f32 v23, v23
    v_exp_f32 v24, v24
    v_mfma_f32_32x32x16_bf16 v[48:63], v[144:147], v[132:135], v[48:63]
    v_exp_f32 v25, v25
    v_exp_f32 v26, v26
    v_exp_f32 v27, v27
    v_exp_f32 v28, v28
    v_smfmac_f32_32x32x32_bf16 v[80:95], v[152:155], v[16:23], v168
    v_exp_f32 v29, v29
    v_exp_f32 v30, v30
    v_exp_f32 v31, v31
    v_exp_f32 v32, v32
    v_exp_f32 v33, v33
    v_smfmac_f32_32x32x32_bf16 v[80:95], v[156:159], v[24:31], v168
    s_waitcnt lgkmcnt(0)
    ds_read_b128 v[152:155], v138 offset:2048
    ds_read_b128 v[156:159], v138 offset:2368
    v_exp_f32 v34, v34
    v_exp_f32 v35, v35
    v_exp_f32 v36, v36
    v_exp_f32 v37, v37
    v_mfma_f32_32x32x4_2b_bf16 v[0:31], v[148:149], v[136:137], v[96:127] cbsz:1 abid:0
    v_exp_f32 v38, v38
    v_exp_f32 v39, v39
    v_exp_f32 v40, v40
    v_exp_f32 v41, v41
    v_exp_f32 v42, v42
    v_exp_f32 v43, v43
    v_exp_f32 v44, v44
    v_exp_f32 v45, v45
    v_smfmac_f32_32x32x32_bf16 v[64:79], v[160:163], v[32:39], v168
    ds_read_b128 v[144:147], v169 offset:512
    v_exp_f32 v46, v46
    v_exp_f32 v47, v47
    v_exp_f32 v48, v48
    v_exp_f32 v49, v49
    v_smfmac_f32_32x32x32_bf16 v[64:79], v[164:167], v[40:47], v168
a_pad1:
    s_cmp_eq_u32 s37, 2
    s_cbranch_scc1 a_back1
    v_exp_f32 v50, v50
    v_exp_f32 v51, v51
    v_exp_f32 v52, v52
    v_exp_f32 v53, v53
    v_mfma_f32_32x32x16_bf16 v[0:15], v[140:143], v[128:131], v[0:15]
    v_exp_f32 v54, v54
    v_exp_f32 v55, v55
    v_exp_f32 v56, v56
    v_mfma_f32_32x32x16_bf16 v[16:31], v[140:143], v[132:135], v[16:31]
    v_exp_f32 v57, v57
    v_exp_f32 v58, v58
    v_exp_f32 v59, v59
    v_exp_f32 v60, v60
    v_smfmac_f32_32x32x32_bf16 v[80:95], v[160:163], v[48:55], v168
    v_exp_f32 v61, v61
    v_exp_f32 v62, v62
    v_exp_f32 v63, v63
    v_exp_f32 v0, v0
    v_exp_f32 v1, v1
    v_smfmac_f32_32x32x32_bf16 v[80:95], v[164:167], v[56:63], v168
    s_waitcnt lgkmcnt(0)
    ds_read_b128 v[160:163], v138 offset:2688
    ds_read_b128 v[164:167], v138 offset:3008
    v_exp_f32 v2, v2
    v_exp_f32 v3, v3
    v_exp_f32 v4, v4
    v_exp_f32 v5, v5
    v_mfma_f32_32x32x4_2b_bf16 v[32:63], v[148:149], v[136:137], v[96:127] cbsz:1 abid:1
    v_exp_f32 v6, v6
    v_exp_f32 v7, v7
    v_exp_f32 v8, v8
    v_exp_f32 v9, v9
    v_exp_f32 v10, v10
    v_exp_f32 v11, v11
    v_exp_f32 v12, v12
    v_exp_f32 v13, v13
    v_smfmac_f32_32x32x32_bf16 v[64:79], v[152:155], v[0:7], v168
    ds_read_b128 v[140:143], v169 offset:1024
    v_exp_f32 v14, v14
    v_exp_f32 v15, v15
    v_exp_f32 v16, v16
    v_exp_f32 v17, v17
    v_smfmac_f32_32x32x32_bf16 v[64:79], v[156:159], v[8:15], v168
    v_exp_f32 v18, v18
    v_exp_f32 v19, v19
    v_exp_f32 v20, v20
    v_exp_f32 v21, v21
    v_mfma_f32_32x32x16_bf16 v[32:47], v[144:147], v[128:131], v[32:47]
    v_exp_f32 v22, v22
    v_exp_f32 v23, v23
    v_exp_f32 v24, v24
    v_mfma_f32_32x32x16_bf16 v[48:63], v[144:147], v[132:135], v[48:63]
    v_exp_f32 v25, v25
    v_exp_f32 v26, v26
    v_exp_f32 v27, v27
    v_exp_f32 v28, v28
    v_smfmac_f32_32x32x32_bf16 v[80:95], v[152:155], v[16:23], v168
    v_exp_f32 v29, v29
    v_exp_f32 v30, v30
    v_exp_f32 v31, v31
    v_exp_f32 v32, v32
    v_exp_f32 v33, v33
    v_smfmac_f32_32x32x32_bf16 v[80:95], v[156:159], v[24:31], v168
    s_waitcnt lgkmcnt(0)
    ds_read_b128 v[152:155], v138 offset:3328
    ds_read_b128 v[156:159], v138 offset:3648
    v_exp_f32 v34, v34
    v_exp_f32 v35, v35
    v_exp_f32 v36, v36
    v_exp_f32 v37, v37
    v_mfma_f32_32x32x4_2b_bf16 v[0:31], v[150:151], v[136:137], v[96:127] cbsz:1 abid:0
    v_exp_f32 v38, v38
    v_exp_f32 v39, v39
    v_exp_f32 v40, v40
    v_exp_f32 v41, v41
    v_exp_f32 v42, v42
    v_exp_f32 v43, v43
    v_exp_f32 v44, v44
    v_exp_f32 v45, v45
    v_smfmac_f32_32x32x32_bf16 v[64:79], v[160:163], v[32:39], v168
    ds_read_b128 v[144:147], v169 offset:1536
    v_exp_f32 v46, v46
    v_exp_f32 v47, v47
    v_exp_f32 v48, v48
    v_exp_f32 v49, v49
    v_smfmac_f32_32x32x32_bf16 v[64:79], v[164:167], v[40:47], v168
    s_mov_b32 s41, 10240
    v_exp_f32 v50, v50
    v_exp_f32 v51, v51
    v_exp_f32 v52, v52
    v_exp_f32 v53, v53
    v_mfma_f32_32x32x16_bf16 v[0:15], v[140:143], v[128:131], v[0:15]
    v_exp_f32 v54, v54
    v_exp_f32 v55, v55
    v_exp_f32 v56, v56
    v_mfma_f32_32x32x16_bf16 v[16:31], v[140:143], v[132:135], v[16:31]
    v_exp_f32 v57, v57
    v_exp_f32 v58, v58
    v_exp_f32 v59, v59
    v_exp_f32 v60, v60
    v_smfmac_f32_32x32x32_bf16 v[80:95], v[160:163], v[48:55], v168
    v_exp_f32 v61, v61
    v_exp_f32 v62, v62
    v_exp_f32 v63, v63
    v_exp_f32 v0, v0
    v_exp_f32 v1, v1
    v_smfmac_f32_32x32x32_bf16 v[80:95], v[164:167], v[56:63], v168
    s_waitcnt lgkmcnt(0)
    ds_read_b128 v[160:163], v138 offset:3968
    ds_read_b128 v[164:167], v138 offset:4288
    v_exp_f32 v2, v2
    v_exp_f32 v3, v3
    v_exp_f32 v4, v4
    v_exp_f32 v5, v5
    v_mfma_f32_32x32x4_2b_bf16 v[32:63], v[150:151], v[136:137], v[96:127] cbsz:1 abid:1
    v_exp_f32 v6, v6
    v_exp_f32 v7, v7
    v_exp_f32 v8, v8
    v_exp_f32 v9, v9
    v_exp_f32 v10, v10
    v_exp_f32 v11, v11
    v_exp_f32 v12, v12
    v_exp_f32 v13, v13
    v_mad_i32_i24 v138, v139, s41, v138
    v_smfmac_f32_32x32x32_bf16 v[64:79], v[152:155], v[0:7], v168
    ds_read_b128 v[140:143], v169 offset:10240
    ds_read_b128 v[172:175], v169 offset:14848
    v_exp_f32 v14, v14
    v_exp_f32 v15, v15
    v_exp_f32 v16, v16
    v_exp_f32 v17, v17
    v_smfmac_f32_32x32x32_bf16 v[64:79], v[156:159], v[8:15], v168
    v_exp_f32 v18, v18
    v_exp_f32 v19, v19
    v_exp_f32 v20, v20
    v_exp_f32 v21, v21
    v_mfma_f32_32x32x16_bf16 v[32:47], v[144:147], v[128:131], v[32:47]
    v_exp_f32 v22, v22
    v_exp_f32 v23, v23
    v_exp_f32 v24, v24
    v_mfma_f32_32x32x16_bf16 v[48:63], v[144:147], v[132:135], v[48:63]
    v_exp_f32 v25, v25
    v_exp_f32 v26, v26
    v_exp_f32 v27, v27
    v_exp_f32 v28, v28
    v_smfmac_f32_32x32x32_bf16 v[80:95], v[152:155], v[16:23], v168
    v_exp_f32 v29, v29
    v_exp_f32 v30, v30
    v_exp_f32 v31, v31
    v_exp_f32 v32, v32
    v_exp_f32 v33, v33
    v_smfmac_f32_32x32x32_bf16 v[80:95], v[156:159], v[24:31], v168
    s_waitcnt lgkmcnt(0)
    ds_read_b128 v[152:155], v138 offset:2048
    ds_read_b128 v[156:159], v138 offset:2368
    v_exp_f32 v34, v34
    v_exp_f32 v35, v35
    v_exp_f32 v36, v36
    v_exp_f32 v37, v37
    v_mfma_f32_32x32x4_2b_bf16 v[0:31], v[172:173], v[136:137], v[96:127] cbsz:1 abid:0
    v_exp_f32 v38, v38
    v_exp_f32 v39, v39
    v_exp_f32 v40, v40
    v_exp_f32 v41, v41
    v_exp_f32 v42, v42
    v_exp_f32 v43, v43
    v_exp_f32 v44, v44
    v_exp_f32 v45, v45
    v_smfmac_f32_32x32x32_bf16 v[64:79], v[160:163], v[32:39], v168
    ds_read_b128 v[144:147], v169 offset:10752
    ds_write_b32 v207, v206 offset:64
    v_exp_f32 v46, v46
    v_exp_f32 v47, v47
    v_exp_f32 v48, v48
    v_exp_f32 v49, v49
    v_smfmac_f32_32x32x32_bf16 v[64:79], v[164:167], v[40:47], v168
    v_exp_f32 v50, v50
    v_exp_f32 v51, v51
    v_exp_f32 v52, v52
    v_exp_f32 v53, v53
    v_mfma_f32_32x32x16_bf16 v[0:15], v[140:143], v[128:131], v[0:15]
    v_exp_f32 v54, v54
    v_exp_f32 v55, v55
    v_exp_f32 v56, v56
    v_mfma_f32_32x32x16_bf16 v[16:31], v[140:143], v[132:135], v[16:31]
    v_exp_f32 v57, v57
    v_exp_f32 v58, v58
    v_exp_f32 v59, v59
    v_exp_f32 v60, v60
    v_smfmac_f32_32x32x32_bf16 v[80:95], v[160:163], v[48:55], v168
    v_exp_f32 v61, v61
    v_exp_f32 v62, v62
    v_exp_f32 v63, v63
    v_exp_f32 v0, v0
    v_exp_f32 v1, v1
    v_smfmac_f32_32x32x32_bf16 v[80:95], v[164:167], v[56:63], v168
    s_waitcnt lgkmcnt(0)
    ds_read_b128 v[160:163], v138 offset:2688
    ds_read_b128 v[164:167], v138 offset:3008
    v_exp_f32 v2, v2
    v_exp_f32 v3, v3
    v_exp_f32 v4, v4
    v_exp_f32 v5, v5
    v_mfma_f32_32x32x4_2b_bf16 v[32:63], v[172:173], v[136:137], v[96:127] cbsz:1 abid:1
    v_exp_f32 v6, v6
    v_exp_f32 v7, v7
    v_exp_f32 v8, v8
    v_exp_f32 v9, v9
    v_exp_f32 v10, v10
    v_exp_f32 v11, v11
    v_exp_f32 v12, v12
    v_exp_f32 v13, v13
    v_smfmac_f32_32x32x32_bf16 v[64:79], v[152:155], v[0:7], v168
    ds_read_b128 v[140:143], v169 offset:11264
    v_exp_f32 v14, v14
    v_exp_f32 v15, v15
    v_exp_f32 v16, v16
    v_exp_f32 v17, v17
    v_smfmac_f32_32x32x32_bf16 v[64:79], v[156:159], v[8:15], v168
    v_exp_f32 v18, v18
    v_exp_f32 v19, v19
    v_exp_f32 v20, v20
    v_exp_f32 v21, v21
    v_mfma_f32_32x32x16_bf16 v[32:47], v[144:147], v[128:131], v[32:47]
    v_exp_f32 v22, v22
    v_exp_f32 v23, v23
    v_exp_f32 v24, v24
    v_mfma_f32_32x32x16_bf16 v[48:63], v[144:147], v[132:135], v[48:63]
    v_exp_f32 v25, v25
    v_exp_f32 v26, v26
    v_exp_f32 v27, v27
    v_exp_f32 v28, v28
    v_smfmac_f32_32x32x32_bf16 v[80:95], v[152:155], v[16:23], v168
    v_exp_f32 v29, v29
    v_exp_f32 v30, v30
    v_exp_f32 v31, v31
    v_exp_f32 v32, v32
    v_exp_f32 v33, v33
    v_smfmac_f32_32x32x32_bf16 v[80:95], v[156:159], v[24:31], v168
    s_waitcnt lgkmcnt(0)
    ds_read_b128 v[152:155], v138 offset:3328
    ds_read_b128 v[156:159], v138 offset:3648
    v_exp_f32 v34, v34
    v_exp_f32 v35, v35
    v_exp_f32 v36, v36
    v_exp_f32 v37, v37
    v_mfma_f32_32x32x4_2b_bf16 v[0:31], v[174:175], v[136:137], v[96:127] cbsz:1 abid:0
    v_exp_f32 v38, v38
    v_exp_f32 v39, v39
    v_exp_f32 v40, v40
    v_exp_f32 v41, v41
    v_exp_f32 v42, v42
    v_exp_f32 v43, v43
    v_exp_f32 v44, v44
    v_exp_f32 v45, v45
    v_smfmac_f32_32x32x32_bf16 v[64:79], v[160:163], v[32:39], v168
    ds_read_b128 v[144:147], v169 offset:11776
    ds_read_b32 v212, v255 offset:80
    v_exp_f32 v46, v46
    v_exp_f32 v47, v47
    v_exp_f32 v48, v48
    v_exp_f32 v49, v49
    v_smfmac_f32_32x32x32_bf16 v[64:79], v[164:167], v[40:47], v168
    s_mov_b32 s41, 10240
    v_exp_f32 v50, v50
    v_exp_f32 v51, v51
    v_exp_f32 v52, v52
    v_exp_f32 v53, v53
    v_mfma_f32_32x32x16_bf16 v[0:15], v[140:143], v[128:131], v[0:15]
    v_exp_f32 v54, v54
    v_exp_f32 v55, v55
    v_exp_f32 v56, v56
    v_mfma_f32_32x32x16_bf16 v[16:31], v[140:143], v[132:135], v[16:31]
    v_exp_f32 v57, v57
    v_exp_f32 v58, v58
    v_exp_f32 v59, v59
    v_exp_f32 v60, v60
    v_smfmac_f32_32x32x32_bf16 v[80:95], v[160:163], v[48:55], v168
    v_exp_f32 v61, v61
    v_exp_f32 v62, v62
    v_exp_f32 v63, v63
    v_exp_f32 v0, v0
    v_exp_f32 v1, v1
    v_smfmac_f32_32x32x32_bf16 v[80:95], v[164:167], v[56:63], v168
    s_waitcnt lgkmcnt(0)
    ds_read_b128 v[160:163], v138 offset:3968
    ds_read_b128 v[164:167], v138 offset:4288
    v_exp_f32 v2, v2
    v_exp_f32 v3, v3
    v_exp_f32 v4, v4
    v_exp_f32 v5, v5
    v_mfma_f32_32x32x4_2b_bf16 v[32:63], v[174:175], v[136:137], v[96:127] cbsz:1 abid:1
    v_exp_f32 v6, v6
    v_exp_f32 v7, v7
    v_exp_f32 v8, v8
    v_exp_f32 v9, v9
    v_exp_f32 v10, v10
    v_exp_f32 v11, v11
    v_exp_f32 v12, v12
    v_exp_f32 v13, v13
    v_mad_i32_i24 v138, v139, s41, v138
    v_smfmac_f32_32x32x32_bf16 v[64:79], v[152:155], v[0:7], v168
    v_cmp_ne_u32 vcc, -1, v212
    s_nop 0
    s_cmp_eq_u64 vcc, 0
    s_cbranch_scc0 a_fk_w
a_fk_r:
    ds_read_b128 v[140:143], v169 offset:20480
    ds_read_b128 v[148:151], v169 offset:25088
    v_exp_f32 v14, v14
    v_exp_f32 v15, v15
    v_exp_f32 v16, v16
    v_exp_f32 v17, v17
    v_smfmac_f32_32x32x32_bf16 v[64:79], v[156:159], v[8:15], v168
    v_exp_f32 v18, v18
    v_exp_f32 v19, v19
    v_exp_f32 v20, v20
    v_exp_f32 v21, v21
    v_mfma_f32_32x32x16_bf16 v[32:47], v[144:147], v[128:131], v[32:47]
    v_exp_f32 v22, v22
    v_exp_f32 v23, v23
    v_exp_f32 v24, v24
    v_mfma_f32_32x32x16_bf16 v[48:63], v[144:147], v[132:135], v[48:63]
    v_exp_f32 v25, v25
    v_exp_f32 v26, v26
    v_exp_f32 v27, v27
    v_exp_f32 v28, v28
    v_smfmac_f32_32x32x32_bf16 v[80:95], v[152:155], v[16:23], v168
    v_exp_f32 v29, v29
    v_exp_f32 v30, v30
    v_exp_f32 v31, v31
    v_exp_f32 v32, v32
    v_exp_f32 v33, v33
    v_smfmac_f32_32x32x32_bf16 v[80:95], v[156:159], v[24:31], v168
    s_waitcnt lgkmcnt(0)
    ds_read_b128 v[152:155], v138 offset:2048
    ds_read_b128 v[156:159], v138 offset:2368
    v_exp_f32 v34, v34
    v_exp_f32 v35, v35
    v_exp_f32 v36, v36
    v_exp_f32 v37, v37
    v_mfma_f32_32x32x4_2b_bf16 v[0:31], v[148:149], v[136:137], v[96:127] cbsz:1 abid:0
    v_exp_f32 v38, v38
    v_exp_f32 v39, v39
    v_exp_f32 v40, v40
    v_exp_f32 v41, v41
    v_exp_f32 v42, v42
    v_exp_f32 v43, v43
    v_exp_f32 v44, v44
    v_exp_f32 v45, v45
    v_smfmac_f32_32x32x32_bf16 v[64:79], v[160:163], v[32:39], v168
    ds_read_b128 v[144:147], v169 offset:20992
    v_exp_f32 v46, v46
    v_exp_f32 v47, v47
    v_exp_f32 v48, v48
    v_exp_f32 v49, v49
    v_smfmac_f32_32x32x32_bf16 v[64:79], v[164:167], v[40:47], v168
    v_exp_f32 v50, v50
    v_exp_f32 v51, v51
    v_exp_f32 v52, v52
    v_exp_f32 v53, v53
    v_mfma_f32_32x32x16_bf16 v[0:15], v[140:143], v[128:131], v[0:15]
    v_exp_f32 v54, v54
    v_exp_f32 v55, v55
    v_exp_f32 v56, v56
    v_mfma_f32_32x32x16_bf16 v[16:31], v[140:143], v[132:135], v[16:31]
    v_exp_f32 v57, v57
    v_exp_f32 v58, v58
    v_exp_f32 v59, v59
    v_exp_f32 v60, v60
    v_smfmac_f32_32x32x32_bf16 v[80:95], v[160:163], v[48:55], v168
    v_exp_f32 v61, v61
    v_exp_f32 v62, v62
    v_exp_f32 v63, v63
    v_exp_f32 v0, v0
    v_exp_f32 v1, v1
    v_smfmac_f32_32x32x32_bf16 v[80:95], v[164:167], v[56:63], v168
    s_waitcnt lgkmcnt(0)
    ds_read_b128 v[160:163], v138 offset:2688
    ds_read_b128 v[164:167], v138 offset:3008
    v_exp_f32 v2, v2
    v_exp_f32 v3, v3
    v_exp_f32 v4, v4
    v_exp_f32 v5, v5
    v_mfma_f32_32x32x4_2b_bf16 v[32:63], v[148:149], v[136:137], v[96:127] cbsz:1 abid:1
    v_exp_f32 v6, v6
    v_exp_f32 v7, v7
    v_exp_f32 v8, v8
    v_exp_f32 v9, v9
    v_exp_f32 v10, v10
    v_exp_f32 v11, v11
    v_exp_f32 v12, v12
    v_exp_f32 v13, v13
    v_smfmac_f32_32x32x32_bf16 v[64:79], v[152:155], v[0:7], v168
    ds_read_b128 v[140:143], v169 offset:21504
    v_exp_f32 v14, v14
    v_exp_f32 v15, v15
    v_exp_f32 v16, v16
    v_exp_f32 v17, v17
    v_smfmac_f32_32x32x32_bf16 v[64:79], v[156:159], v[8:15], v168
    v_exp_f32 v18, v18
    v_exp_f32 v19, v19
    v_exp_f32 v20, v20
    v_exp_f32 v21, v21
    v_mfma_f32_32x32x16_bf16 v[32:47], v[144:147], v[128:131], v[32:47]
    v_exp_f32 v22, v22
    v_exp_f32 v23, v23
    v_exp_f32 v24, v24
    v_mfma_f32_32x32x16_bf16 v[48:63], v[144:147], v[132:135], v[48:63]
    v_exp_f32 v25, v25
    v_exp_f32 v26, v26
    v_exp_f32 v27, v27
    v_exp_f32 v28, v28
    v_smfmac_f32_32x32x32_bf16 v[80:95], v[152:155], v[16:23], v168
    v_exp_f32 v29, v29
    v_exp_f32 v30, v30
    v_exp_f32 v31, v31
    v_exp_f32 v32, v32
    v_exp_f32 v33, v33
    v_smfmac_f32_32x32x32_bf16 v[80:95], v[156:159], v[24:31], v168
    s_waitcnt lgkmcnt(0)
    ds_read_b128 v[152:155], v138 offset:3328
    ds_read_b128 v[156:159], v138 offset:3648
    v_exp_f32 v34, v34
    v_exp_f32 v35, v35
    v_exp_f32 v36, v36
    v_exp_f32 v37, v37
    v_mfma_f32_32x32x4_2b_bf16 v[0:31], v[150:151], v[136:137], v[96:127] cbsz:1 abid:0
    v_exp_f32 v38, v38
    v_exp_f32 v39, v39
    v_exp_f32 v40, v40
    v_exp_f32 v41, v41
    v_exp_f32 v42, v42
    v_exp_f32 v43, v43
    v_exp_f32 v44, v44
    v_exp_f32 v45, v45
    v_smfmac_f32_32x32x32_bf16 v[64:79], v[160:163], v[32:39], v168
    ds_read_b128 v[144:147], v169 offset:22016
    v_exp_f32 v46, v46
    v_exp_f32 v47, v47
    v_exp_f32 v48, v48
    v_exp_f32 v49, v49
    v_smfmac_f32_32x32x32_bf16 v[64:79], v[164:167], v[40:47], v168
    s_mov_b32 s41, 10240
    v_exp_f32 v50, v50
    v_exp_f32 v51, v51
    v_exp_f32 v52, v52
    v_exp_f32 v53, v53
    v_mfma_f32_32x32x16_bf16 v[0:15], v[140:143], v[128:131], v[0:15]
    v_exp_f32 v54, v54
    v_exp_f32 v55, v55
    v_exp_f32 v56, v56
    v_mfma_f32_32x32x16_bf16 v[16:31], v[140:143], v[132:135], v[16:31]
    v_exp_f32 v57, v57
    v_exp_f32 v58, v58
    v_exp_f32 v59, v59
    v_exp_f32 v60, v60
    v_smfmac_f32_32x32x32_bf16 v[80:95], v[160:163], v[48:55], v168
    v_exp_f32 v61, v61
    v_exp_f32 v62, v62
    v_exp_f32 v63, v63
    v_exp_f32 v0, v0
    v_exp_f32 v1, v1
    v_smfmac_f32_32x32x32_bf16 v[80:95], v[164:167], v[56:63], v168
    s_waitcnt lgkmcnt(0)
    ds_read_b128 v[160:163], v138 offset:3968
    ds_read_b128 v[164:167], v138 offset:4288
    v_exp_f32 v2, v2
    v_exp_f32 v3, v3
    v_exp_f32 v4, v4
    v_exp_f32 v5, v5
    v_mfma_f32_32x32x4_2b_bf16 v[32:63], v[150:151], v[136:137], v[96:127] cbsz:1 abid:1
    v_exp_f32 v6, v6
    v_exp_f32 v7, v7
    v_exp_f32 v8, v8
    v_exp_f32 v9, v9
    v_exp_f32 v10, v10
    v_exp_f32 v11, v11
    v_exp_f32 v12, v12
    v_exp_f32 v13, v13
    v_mad_i32_i24 v138, v139, s41, v138
    v_smfmac_f32_32x32x32_bf16 v[64:79], v[152:155], v[0:7], v168
    ds_read_b128 v[140:143], v169 offset:30720
    ds_read_b128 v[172:175], v169 offset:35328
    v_exp_f32 v14, v14
    v_exp_f32 v15, v15
    v_exp_f32 v16, v16
    v_exp_f32 v17, v17
    v_smfmac_f32_32x32x32_bf16 v[64:79], v[156:159], v[8:15], v168
    v_exp_f32 v18, v18
    v_exp_f32 v19, v19
    v_exp_f32 v20, v20
    v_exp_f32 v21, v21
    v_mfma_f32_32x32x16_bf16 v[32:47], v[144:147], v[128:131], v[32:47]
    v_exp_f32 v22, v22
    v_exp_f32 v23, v23
    v_exp_f32 v24, v24
    v_mfma_f32_32x32x16_bf16 v[48:63], v[144:147], v[132:135], v[48:63]
    v_exp_f32 v25, v25
    v_exp_f32 v26, v26
    v_exp_f32 v27, v27
    v_exp_f32 v28, v28
    v_smfmac_f32_32x32x32_bf16 v[80:95], v[152:155], v[16:23], v168
    v_exp_f32 v29, v29
    v_exp_f32 v30, v30
    v_exp_f32 v31, v31
    v_exp_f32 v32, v32
    v_exp_f32 v33, v33
    v_smfmac_f32_32x32x32_bf16 v[80:95], v[156:159], v[24:31], v168
    s_waitcnt lgkmcnt(0)
    ds_read_b128 v[152:155], v138 offset:2048
    ds_read_b128 v[156:159], v138 offset:2368
    v_exp_f32 v34, v34
    v_exp_f32 v35, v35
    v_exp_f32 v36, v36
    v_exp_f32 v37, v37
    v_mfma_f32_32x32x4_2b_bf16 v[0:31], v[172:173], v[136:137], v[96:127] cbsz:1 abid:0
    v_exp_f32 v38, v38
    v_exp_f32 v39, v39
    v_exp_f32 v40, v40
    v_exp_f32 v41, v41
    v_exp_f32 v42, v42
    v_exp_f32 v43, v43
    v_exp_f32 v44, v44
    v_exp_f32 v45, v45
    v_smfmac_f32_32x32x32_bf16 v[64:79], v[160:163], v[32:39], v168
    ds_read_b128 v[144:147], v169 offset:31232
    v_exp_f32 v46, v46
    v_exp_f32 v47, v47
    v_exp_f32 v48, v48
    v_exp_f32 v49, v49
    v_smfmac_f32_32x32x32_bf16 v[64:79], v[164:167], v[40:47], v168
    v_exp_f32 v50, v50
    v_exp_f32 v51, v51
    v_exp_f32 v52, v52
    v_exp_f32 v53, v53
    v_mfma_f32_32x32x16_bf16 v[0:15], v[140:143], v[128:131], v[0:15]
    v_exp_f32 v54, v54
    v_exp_f32 v55, v55
    v_exp_f32 v56, v56
    v_mfma_f32_32x32x16_bf16 v[16:31], v[140:143], v[132:135], v[16:31]
    v_exp_f32 v57, v57
    v_exp_f32 v58, v58
    v_exp_f32 v59, v59
    v_exp_f32 v60, v60
    v_smfmac_f32_32x32x32_bf16 v[80:95], v[160:163], v[48:55], v168
    v_exp_f32 v61, v61
    v_exp_f32 v62, v62
    v_exp_f32 v63, v63
    v_exp_f32 v0, v0
    v_exp_f32 v1, v1
    v_smfmac_f32_32x32x32_bf16 v[80:95], v[164:167], v[56:63], v168
    s_waitcnt lgkmcnt(0)
    ds_read_b128 v[160:163], v138 offset:2688
    ds_read_b128 v[164:167], v138 offset:3008
    v_exp_f32 v2, v2
    v_exp_f32 v3, v3
    v_exp_f32 v4, v4
    v_exp_f32 v5, v5
    v_mfma_f32_32x32x4_2b_bf16 v[32:63], v[172:173], v[136:137], v[96:127] cbsz:1 abid:1
    v_exp_f32 v6, v6
    v_exp_f32 v7, v7
    v_exp_f32 v8, v8
    v_exp_f32 v9, v9
    v_exp_f32 v10, v10
    v_exp_f32 v11, v11
    v_exp_f32 v12, v12
    v_exp_f32 v13, v13
    v_smfmac_f32_32x32x32_bf16 v[64:79], v[152:155], v[0:7], v168
    ds_read_b128 v[140:143], v169 offset:31744
    v_exp_f32 v14, v14
    v_exp_f32 v15, v15
    v_exp_f32 v16, v16
    v_exp_f32 v17, v17
    v_smfmac_f32_32x32x32_bf16 v[64:79], v[156:159], v[8:15], v168
    v_exp_f32 v18, v18
    v_exp_f32 v19, v19
    v_exp_f32 v20, v20
    v_exp_f32 v21, v21
    v_mfma_f32_32x32x16_bf16 v[32:47], v[144:147], v[128:131], v[32:47]
    v_exp_f32 v22, v22
    v_exp_f32 v23, v23
    v_exp_f32 v24, v24
    v_mfma_f32_32x32x16_bf16 v[48:63], v[144:147], v[132:135], v[48:63]
    v_exp_f32 v25, v25
    v_exp_f32 v26, v26
    v_exp_f32 v27, v27
    v_exp_f32 v28, v28
    v_smfmac_f32_32x32x32_bf16 v[80:95], v[152:155], v[16:23], v168
    v_exp_f32 v29, v29
    v_exp_f32 v30, v30
    v_exp_f32 v31, v31
    v_exp_f32 v32, v32
    v_exp_f32 v33, v33
    v_smfmac_f32_32x32x32_bf16 v[80:95], v[156:159], v[24:31], v168
    s_waitcnt lgkmcnt(0)
    ds_read_b128 v[152:155], v138 offset:3328
    ds_read_b128 v[156:159], v138 offset:3648
    v_exp_f32 v34, v34
    v_exp_f32 v35, v35
    v_exp_f32 v36, v36
    v_exp_f32 v37, v37
    v_mfma_f32_32x32x4_2b_bf16 v[0:31], v[174:175], v[136:137], v[96:127] cbsz:1 abid:0
    v_exp_f32 v38, v38
    v_exp_f32 v39, v39
    v_exp_f32 v40, v40
    v_exp_f32 v41, v41
    v_exp_f32 v42, v42
    v_exp_f32 v43, v43
    v_exp_f32 v44, v44
    v_exp_f32 v45, v45
    v_smfmac_f32_32x32x32_bf16 v[64:79], v[160:163], v[32:39], v168
    ds_read_b128 v[144:147], v169 offset:32256
    v_exp_f32 v46, v46
    v_exp_f32 v47, v47
    v_exp_f32 v48, v48
    v_exp_f32 v49, v49
    v_smfmac_f32_32x32x32_bf16 v[64:79], v[164:167], v[40:47], v168
    s_mov_b32 s41, 10240
    v_exp_f32 v50, v50
    v_exp_f32 v51, v51
    v_exp_f32 v52, v52
    v_exp_f32 v53, v53
    v_mfma_f32_32x32x16_bf16 v[0:15], v[140:143], v[128:131], v[0:15]
    v_exp_f32 v54, v54
    v_exp_f32 v55, v55
    v_exp_f32 v56, v56
    v_mfma_f32_32x32x16_bf16 v[16:31], v[140:143], v[132:135], v[16:31]
    v_exp_f32 v57, v57
    v_exp_f32 v58, v58
    v_exp_f32 v59, v59
    v_exp_f32 v60, v60
    v_smfmac_f32_32x32x32_bf16 v[80:95], v[160:163], v[48:55], v168
    v_exp_f32 v61, v61
    v_exp_f32 v62, v62
    v_exp_f32 v63, v63
    v_exp_f32 v0, v0
    v_exp_f32 v1, v1
    v_smfmac_f32_32x32x32_bf16 v[80:95], v[164:167], v[56:63], v168
    s_waitcnt lgkmcnt(0)
    ds_read_b128 v[160:163], v138 offset:3968
    ds_read_b128 v[164:167], v138 offset:4288
    v_exp_f32 v2, v2
    v_exp_f32 v3, v3
    v_exp_f32 v4, v4
    v_exp_f32 v5, v5
    v_mfma_f32_32x32x4_2b_bf16 v[32:63], v[174:175], v[136:137], v[96:127] cbsz:1 abid:1
    v_exp_f32 v6, v6
    v_exp_f32 v7, v7
    v_exp_f32 v8, v8
    v_exp_f32 v9, v9
    v_exp_f32 v10, v10
    v_exp_f32 v11, v11
    v_exp_f32 v12, v12
    v_exp_f32 v13, v13
    v_mad_i32_i24 v138, v139, s41, v138
    v_smfmac_f32_32x32x32_bf16 v[64:79], v[152:155], v[0:7], v168
    ds_read_b128 v[140:143], v169 offset:40960
    ds_read_b128 v[148:151], v169 offset:45568
    v_exp_f32 v14, v14
    v_exp_f32 v15, v15
    v_exp_f32 v16, v16
    v_exp_f32 v17, v17
    v_smfmac_f32_32x32x32_bf16 v[64:79], v[156:159], v[8:15], v168
    v_exp_f32 v18, v18
    v_exp_f32 v19, v19
    v_exp_f32 v20, v20
    v_exp_f32 v21, v21
    v_mfma_f32_32x32x16_bf16 v[32:47], v[144:147], v[128:131], v[32:47]
    v_exp_f32 v22, v22
    v_exp_f32 v23, v23
    v_exp_f32 v24, v24
    v_mfma_f32_32x32x16_bf16 v[48:63], v[144:147], v[132:135], v[48:63]
    v_exp_f32 v25, v25
    v_exp_f32 v26, v26
    v_exp_f32 v27, v27
    v_exp_f32 v28, v28
    v_smfmac_f32_32x32x32_bf16 v[80:95], v[152:155], v[16:23], v168
    v_exp_f32 v29, v29
    v_exp_f32 v30, v30
    v_exp_f32 v31, v31
    v_exp_f32 v32, v32
    v_exp_f32 v33, v33
    v_smfmac_f32_32x32x32_bf16 v[80:95], v[156:159], v[24:31], v168
    s_waitcnt lgkmcnt(0)
    ds_read_b128 v[152:155], v138 offset:2048
    ds_read_b128 v[156:159], v138 offset:2368
    v_exp_f32 v34, v34
    v_exp_f32 v35, v35
    v_exp_f32 v36, v36
    v_exp_f32 v37, v37
    v_mfma_f32_32x32x4_2b_bf16 v[0:31], v[148:149], v[136:137], v[96:127] cbsz:1 abid:0
    v_exp_f32 v38, v38
    v_exp_f32 v39, v39
    v_exp_f32 v40, v40
    v_exp_f32 v41, v41
    v_exp_f32 v42, v42
    v_exp_f32 v43, v43
    v_exp_f32 v44, v44
    v_exp_f32 v45, v45
    v_smfmac_f32_32x32x32_bf16 v[64:79], v[160:163], v[32:39], v168
    ds_read_b128 v[144:147], v169 offset:41472
    v_exp_f32 v46, v46
    v_exp_f32 v47, v47
    v_exp_f32 v48, v48
    v_exp_f32 v49, v49
    v_smfmac_f32_32x32x32_bf16 v[64:79], v[164:167], v[40:47], v168
    v_exp_f32 v50, v50
    v_exp_f32 v51, v51
    v_exp_f32 v52, v52
    v_exp_f32 v53, v53
    v_mfma_f32_32x32x16_bf16 v[0:15], v[140:143], v[128:131], v[0:15]
    v_exp_f32 v54, v54
    v_exp_f32 v55, v55
    v_exp_f32 v56, v56
    v_mfma_f32_32x32x16_bf16 v[16:31], v[140:143], v[132:135], v[16:31]
    v_exp_f32 v57, v57
    v_exp_f32 v58, v58
    v_exp_f32 v59, v59
    v_exp_f32 v60, v60
    v_smfmac_f32_32x32x32_bf16 v[80:95], v[160:163], v[48:55], v168
    v_exp_f32 v61, v61
    v_exp_f32 v62, v62
    v_exp_f32 v63, v63
    v_exp_f32 v0, v0
    v_exp_f32 v1, v1
    v_smfmac_f32_32x32x32_bf16 v[80:95], v[164:167], v[56:63], v168
    s_waitcnt lgkmcnt(0)
    ds_read_b128 v[160:163], v138 offset:2688
    ds_read_b128 v[164:167], v138 offset:3008
    v_exp_f32 v2, v2
    v_exp_f32 v3, v3
    v_exp_f32 v4, v4
    v_exp_f32 v5, v5
    v_mfma_f32_32x32x4_2b_bf16 v[32:63], v[148:149], v[136:137], v[96:127] cbsz:1 abid:1
    v_exp_f32 v6, v6
    v_exp_f32 v7, v7
    v_exp_f32 v8, v8
    v_exp_f32 v9, v9
    v_exp_f32 v10, v10
    v_exp_f32 v11, v11
    v_exp_f32 v12, v12
    v_exp_f32 v13, v13
    v_smfmac_f32_32x32x32_bf16 v[64:79], v[152:155], v[0:7], v168
    ds_read_b128 v[140:143], v169 offset:41984
    ds_read_b32 v211, v255 offset:52
    v_exp_f32 v14, v14
    v_exp_f32 v15, v15
    v_exp_f32 v16, v16
    v_exp_f32 v17, v17
    v_smfmac_f32_32x32x32_bf16 v[64:79], v[156:159], v[8:15], v168
    v_exp_f32 v18, v18
    v_exp_f32 v19, v19
    v_exp_f32 v20, v20
    v_exp_f32 v21, v21
    v_mfma_f32_32x32x16_bf16 v[32:47], v[144:147], v[128:131], v[32:47]
    v_exp_f32 v22, v22
    v_exp_f32 v23, v23
    v_exp_f32 v24, v24
    v_mfma_f32_32x32x16_bf16 v[48:63], v[144:147], v[132:135], v[48:63]
    v_exp_f32 v25, v25
    v_exp_f32 v26, v26
    v_exp_f32 v27, v27
    v_exp_f32 v28, v28
    v_smfmac_f32_32x32x32_bf16 v[80:95], v[152:155], v[16:23], v168
    v_exp_f32 v29, v29
    v_exp_f32 v30, v30
    v_exp_f32 v31, v31
    v_exp_f32 v32, v32
    v_exp_f32 v33, v33
    v_smfmac_f32_32x32x32_bf16 v[80:95], v[156:159], v[24:31], v168
    s_waitcnt lgkmcnt(0)
    ds_read_b128 v[152:155], v138 offset:3328
    ds_read_b128 v[156:159], v138 offset:3648
    v_exp_f32 v34, v34
    v_exp_f32 v35, v35
    v_exp_f32 v36, v36
    v_exp_f32 v37, v37
    v_mfma_f32_32x32x4_2b_bf16 v[0:31], v[150:151], v[136:137], v[96:127] cbsz:1 abid:0
    v_exp_f32 v38, v38
    v_exp_f32 v39, v39
    v_exp_f32 v40, v40
    v_exp_f32 v41, v41
    v_exp_f32 v42, v42
    v_exp_f32 v43, v43
    v_exp_f32 v44, v44
    v_exp_f32 v45, v45
    v_smfmac_f32_32x32x32_bf16 v[64:79], v[160:163], v[32:39], v168
    ds_read_b128 v[144:147], v169 offset:42496
    v_exp_f32 v46, v46
    v_exp_f32 v47, v47
    v_exp_f32 v48, v48
    v_exp_f32 v49, v49
    v_smfmac_f32_32x32x32_bf16 v[64:79], v[164:167], v[40:47], v168
    s_mov_b32 s41, 20480
    v_exp_f32 v50, v50
    v_exp_f32 v51, v51
    v_exp_f32 v52, v52
    v_exp_f32 v53, v53
    v_mfma_f32_32x32x16_bf16 v[0:15], v[140:143], v[128:131], v[0:15]
    v_exp_f32 v54, v54
    v_exp_f32 v55, v55
    v_exp_f32 v56, v56
    v_mfma_f32_32x32x16_bf16 v[16:31], v[140:143], v[132:135], v[16:31]
    v_exp_f32 v57, v57
    v_exp_f32 v58, v58
    v_exp_f32 v59, v59
    v_exp_f32 v60, v60
    v_smfmac_f32_32x32x32_bf16 v[80:95], v[160:163], v[48:55], v168
    v_exp_f32 v61, v61
    v_exp_f32 v62, v62
    v_exp_f32 v63, v63
    v_exp_f32 v0, v0
    v_exp_f32 v1, v1
    v_smfmac_f32_32x32x32_bf16 v[80:95], v[164:167], v[56:63], v168
    s_waitcnt lgkmcnt(0)
    ds_read_b128 v[160:163], v138 offset:3968
    ds_read_b128 v[164:167], v138 offset:4288
    v_exp_f32 v2, v2
    v_exp_f32 v3, v3
a_pad2:
    s_cmp_eq_u32 s37, 2
    s_cbranch_scc1 a_back2
    v_exp_f32 v4, v4
    v_exp_f32 v5, v5
    v_mfma_f32_32x32x4_2b_bf16 v[32:63], v[150:151], v[136:137], v[96:127] cbsz:1 abid:1
    v_exp_f32 v6, v6
    v_exp_f32 v7, v7
    v_exp_f32 v8, v8
    v_exp_f32 v9, v9
    v_exp_f32 v10, v10
    v_exp_f32 v11, v11
    v_exp_f32 v12, v12
    v_exp_f32 v13, v13
    v_mad_i32_i24 v138, v139, s41, v138
    v_add_u32 v169, 61440, v169
    v_smfmac_f32_32x32x32_bf16 v[64:79], v[152:155], v[0:7], v168
    ds_read_b128 v[140:143], v169 offset:0
    ds_read_b128 v[172:175], v169 offset:4608
    v_exp_f32 v14, v14
    v_exp_f32 v15, v15
    v_exp_f32 v16, v16
    v_exp_f32 v17, v17
    v_smfmac_f32_32x32x32_bf16 v[64:79], v[156:159], v[8:15], v168
    v_exp_f32 v18, v18
    v_exp_f32 v19, v19
    v_exp_f32 v20, v20
    v_exp_f32 v21, v21
    v_mfma_f32_32x32x16_bf16 v[32:47], v[144:147], v[128:131], v[32:47]
    v_exp_f32 v22, v22
    v_exp_f32 v23, v23
    v_exp_f32 v24, v24
    v_mfma_f32_32x32x16_bf16 v[48:63], v[144:147], v[132:135], v[48:63]
    v_exp_f32 v25, v25
    v_exp_f32 v26, v26
    v_exp_f32 v27, v27
    v_exp_f32 v28, v28
    v_smfmac_f32_32x32x32_bf16 v[80:95], v[152:155], v[16:23], v168
    v_exp_f32 v29, v29
    v_exp_f32 v30, v30
    v_exp_f32 v31, v31
    v_exp_f32 v32, v32
    v_exp_f32 v33, v33
    v_smfmac_f32_32x32x32_bf16 v[80:95], v[156:159], v[24:31], v168
    s_waitcnt lgkmcnt(0)
    ds_read_b128 v[152:155], v138 offset:2048
    ds_read_b128 v[156:159], v138 offset:2368
    v_exp_f32 v34, v34
    v_exp_f32 v35, v35
    v_exp_f32 v36, v36
    v_exp_f32 v37, v37
    v_mfma_f32_32x32x4_2b_bf16 v[0:31], v[172:173], v[136:137], v[96:127] cbsz:1 abid:0
    v_exp_f32 v38, v38
    v_exp_f32 v39, v39
    v_exp_f32 v40, v40
    v_exp_f32 v41, v41
    v_exp_f32 v42, v42
    v_exp_f32 v43, v43
    v_exp_f32 v44, v44
    v_exp_f32 v45, v45
    v_smfmac_f32_32x32x32_bf16 v[64:79], v[160:163], v[32:39], v168
    ds_read_b128 v[144:147], v169 offset:512
    ds_write_b32 v207, v206 offset:0
    v_exp_f32 v46, v46
    v_exp_f32 v47, v47
    v_exp_f32 v48, v48
    v_exp_f32 v49, v49
    v_smfmac_f32_32x32x32_bf16 v[64:79], v[164:167], v[40:47], v168
    v_exp_f32 v50, v50
    v_exp_f32 v51, v51
    v_exp_f32 v52, v52
    v_exp_f32 v53, v53
    v_mfma_f32_32x32x16_bf16 v[0:15], v[140:143], v[128:131], v[0:15]
    v_exp_f32 v54, v54
    v_exp_f32 v55, v55
    v_exp_f32 v56, v56
    v_mfma_f32_32x32x16_bf16 v[16:31], v[140:143], v[132:135], v[16:31]
    v_exp_f32 v57, v57
    v_exp_f32 v58, v58
    v_exp_f32 v59, v59
    v_exp_f32 v60, v60
    v_smfmac_f32_32x32x32_bf16 v[80:95], v[160:163], v[48:55], v168
    v_exp_f32 v61, v61
    v_exp_f32 v62, v62
    v_exp_f32 v63, v63
    v_exp_f32 v0, v0
    v_exp_f32 v1, v1
    v_smfmac_f32_32x32x32_bf16 v[80:95], v[164:167], v[56:63], v168
    s_waitcnt lgkmcnt(0)
    ds_read_b128 v[160:163], v138 offset:2688
    ds_read_b128 v[164:167], v138 offset:3008
    v_exp_f32 v2, v2
    v_exp_f32 v3, v3
    v_exp_f32 v4, v4
    v_exp_f32 v5, v5
    v_mfma_f32_32x32x4_2b_bf16 v[32:63], v[172:173], v[136:137], v[96:127] cbsz:1 abid:1
    v_exp_f32 v6, v6
    v_exp_f32 v7, v7
    v_exp_f32 v8, v8
    v_exp_f32 v9, v9
    v_exp_f32 v10, v10
    v_exp_f32 v11, v11
    v_exp_f32 v12, v12
    v_exp_f32 v13, v13
    v_smfmac_f32_32x32x32_bf16 v[64:79], v[152:155], v[0:7], v168
    ds_read_b128 v[140:143], v169 offset:1024
    v_exp_f32 v14, v14
    v_exp_f32 v15, v15
    v_exp_f32 v16, v16
    v_exp_f32 v17, v17
    v_smfmac_f32_32x32x32_bf16 v[64:79], v[156:159], v[8:15], v168
    v_exp_f32 v18, v18
    v_exp_f32 v19, v19
    v_exp_f32 v20, v20
    v_exp_f32 v21, v21
    v_mfma_f32_32x32x16_bf16 v[32:47], v[144:147], v[128:131], v[32:47]
    v_exp_f32 v22, v22
    v_exp_f32 v23, v23
    v_exp_f32 v24, v24
    v_mfma_f32_32x32x16_bf16 v[48:63], v[144:147], v[132:135], v[48:63]
    v_exp_f32 v25, v25
    v_exp_f32 v26, v26
    v_exp_f32 v27, v27
    v_exp_f32 v28, v28
    v_smfmac_f32_32x32x32_bf16 v[80:95], v[152:155], v[16:23], v168
    v_exp_f32 v29, v29
    v_exp_f32 v30, v30
    v_exp_f32 v31, v31
    v_exp_f32 v32, v32
    v_exp_f32 v33, v33
    v_smfmac_f32_32x32x32_bf16 v[80:95], v[156:159], v[24:31], v168
    s_waitcnt lgkmcnt(0)
    ds_read_b128 v[152:155], v138 offset:3328
    ds_read_b128 v[156:159], v138 offset:3648
    v_exp_f32 v34, v34
    v_exp_f32 v35, v35
    v_exp_f32 v36, v36
    v_exp_f32 v37, v37
    v_mfma_f32_32x32x4_2b_bf16 v[0:31], v[174:175], v[136:137], v[96:127] cbsz:1 abid:0
    v_exp_f32 v38, v38
    v_exp_f32 v39, v39
    v_exp_f32 v40, v40
    v_exp_f32 v41, v41
    v_exp_f32 v42, v42
    v_exp_f32 v43, v43
    v_exp_f32 v44, v44
    v_exp_f32 v45, v45
    v_smfmac_f32_32x32x32_bf16 v[64:79], v[160:163], v[32:39], v168
    ds_read_b128 v[144:147], v169 offset:1536
    v_exp_f32 v46, v46
    v_exp_f32 v47, v47
    v_exp_f32 v48, v48
    v_exp_f32 v49, v49
    v_smfmac_f32_32x32x32_bf16 v[64:79], v[164:167], v[40:47], v168
    s_mov_b32 s41, 10240
    v_exp_f32 v50, v50
    v_exp_f32 v51, v51
    v_exp_f32 v52, v52
    v_exp_f32 v53, v53
    v_mfma_f32_32x32x16_bf16 v[0:15], v[140:143], v[128:131], v[0:15]
    v_exp_f32 v54, v54
    v_exp_f32 v55, v55
    v_exp_f32 v56, v56
    v_mfma_f32_32x32x16_bf16 v[16:31], v[140:143], v[132:135], v[16:31]
    v_exp_f32 v57, v57
    v_exp_f32 v58, v58
    v_exp_f32 v59, v59
    v_exp_f32 v60, v60
    v_smfmac_f32_32x32x32_bf16 v[80:95], v[160:163], v[48:55], v168
    v_exp_f32 v61, v61
    v_exp_f32 v62, v62
    v_exp_f32 v63, v63
    v_exp_f32 v0, v0
    v_exp_f32 v1, v1
    v_smfmac_f32_32x32x32_bf16 v[80:95], v[164:167], v[56:63], v168
    s_waitcnt lgkmcnt(0)
    ds_read_b128 v[160:163], v138 offset:3968
    ds_read_b128 v[164:167], v138 offset:4288
    v_exp_f32 v2, v2
    v_exp_f32 v3, v3
    v_exp_f32 v4, v4
    v_exp_f32 v5, v5
    v_mfma_f32_32x32x4_2b_bf16 v[32:63], v[174:175], v[136:137], v[96:127] cbsz:1 abid:1
    v_exp_f32 v6, v6
    v_exp_f32 v7, v7
    v_exp_f32 v8, v8
    v_exp_f32 v9, v9
    v_exp_f32 v10, v10
    v_exp_f32 v11, v11
    v_exp_f32 v12, v12
    v_exp_f32 v13, v13
    v_mad_i32_i24 v138, v139, s41, v138
    v_smfmac_f32_32x32x32_bf16 v[64:79], v[152:155], v[0:7], v168
    ds_read_b128 v[140:143], v169 offset:10240
    ds_read_b128 v[148:151], v169 offset:14848
    v_exp_f32 v14, v14
    v_exp_f32 v15, v15
    v_exp_f32 v16, v16
    v_exp_f32 v17, v17
    v_smfmac_f32_32x32x32_bf16 v[64:79], v[156:159], v[8:15], v168
    v_exp_f32 v18, v18
    v_exp_f32 v19, v19
    v_exp_f32 v20, v20
    v_exp_f32 v21, v21
    v_mfma_f32_32x32x16_bf16 v[32:47], v[144:147], v[128:131], v[32:47]
    v_exp_f32 v22, v22
    v_exp_f32 v23, v23
    v_exp_f32 v24, v24
    v_mfma_f32_32x32x16_bf16 v[48:63], v[144:147], v[132:135], v[48:63]
    v_exp_f32 v25, v25
    v_exp_f32 v26, v26
    v_exp_f32 v27, v27
    v_exp_f32 v28, v28
    v_smfmac_f32_32x32x32_bf16 v[80:95], v[152:155], v[16:23], v168
    v_exp_f32 v29, v29
    v_exp_f32 v30, v30
    v_exp_f32 v31, v31
    v_exp_f32 v32, v32
    v_exp_f32 v33, v33
    v_smfmac_f32_32x32x32_bf16 v[80:95], v[156:159], v[24:31], v168
    s_waitcnt lgkmcnt(0)
    ds_read_b128 v[152:155], v138 offset:2048
    ds_read_b128 v[156:159], v138 offset:2368
    v_exp_f32 v34, v34
    v_exp_f32 v35, v35
    v_exp_f32 v36, v36
    v_exp_f32 v37, v37
    v_mfma_f32_32x32x4_2b_bf16 v[0:31], v[148:149], v[136:137], v[96:127] cbsz:1 abid:0
    v_exp_f32 v38, v38
    v_exp_f32 v39, v39
    v_exp_f32 v40, v40
    v_exp_f32 v41, v41
    v_exp_f32 v42, v42
    v_exp_f32 v43, v43
    v_exp_f32 v44, v44
    v_exp_f32 v45, v45
    v_smfmac_f32_32x32x32_bf16 v[64:79], v[160:163], v[32:39], v168
    ds_read_b128 v[144:147], v169 offset:10752
    v_exp_f32 v46, v46
    v_exp_f32 v47, v47
    v_exp_f32 v48, v48
    v_exp_f32 v49, v49
    v_smfmac_f32_32x32x32_bf16 v[64:79], v[164:167], v[40:47], v168
    v_exp_f32 v50, v50
    v_exp_f32 v51, v51
    v_exp_f32 v52, v52
    v_exp_f32 v53, v53
    v_mfma_f32_32x32x16_bf16 v[0:15], v[140:143], v[128:131], v[0:15]
    v_exp_f32 v54, v54
    v_exp_f32 v55, v55
    v_exp_f32 v56, v56
    v_mfma_f32_32x32x16_bf16 v[16:31], v[140:143], v[132:135], v[16:31]
    v_exp_f32 v57, v57
    v_exp_f32 v58, v58
    v_exp_f32 v59, v59
    v_exp_f32 v60, v60
    v_smfmac_f32_32x32x32_bf16 v[80:95], v[160:163], v[48:55], v168
    v_exp_f32 v61, v61
    v_exp_f32 v62, v62
    v_exp_f32 v63, v63
    v_exp_f32 v0, v0
    v_exp_f32 v1, v1
    v_smfmac_f32_32x32x32_bf16 v[80:95], v[164:167], v[56:63], v168
    s_waitcnt lgkmcnt(0)
    ds_read_b128 v[160:163], v138 offset:2688
    ds_read_b128 v[164:167], v138 offset:3008
    v_exp_f32 v2, v2
    v_exp_f32 v3, v3
    v_exp_f32 v4, v4
    v_exp_f32 v5, v5
    v_mfma_f32_32x32x4_2b_bf16 v[32:63], v[148:149], v[136:137], v[96:127] cbsz:1 abid:1
    v_exp_f32 v6, v6
    v_exp_f32 v7, v7
    v_exp_f32 v8, v8
    v_exp_f32 v9, v9
    v_exp_f32 v10, v10
    v_exp_f32 v11, v11
    v_exp_f32 v12, v12
    v_exp_f32 v13, v13
    v_smfmac_f32_32x32x32_bf16 v[64:79], v[152:155], v[0:7], v168
    ds_read_b128 v[140:143], v169 offset:11264
    v_exp_f32 v14, v14
    v_exp_f32 v15, v15
    v_exp_f32 v16, v16
    v_exp_f32 v17, v17
    v_smfmac_f32_32x32x32_bf16 v[64:79], v[156:159], v[8:15], v168
    v_exp_f32 v18, v18
    v_exp_f32 v19, v19
    v_exp_f32 v20, v20
    v_exp_f32 v21, v21
    v_mfma_f32_32x32x16_bf16 v[32:47], v[144:147], v[128:131], v[32:47]
    v_exp_f32 v22, v22
    v_exp_f32 v23, v23
    v_exp_f32 v24, v24
    v_mfma_f32_32x32x16_bf16 v[48:63], v[144:147], v[132:135], v[48:63]
    v_exp_f32 v25, v25
    v_exp_f32 v26, v26
    v_exp_f32 v27, v27
    v_exp_f32 v28, v28
    v_smfmac_f32_32x32x32_bf16 v[80:95], v[152:155], v[16:23], v168
    v_exp_f32 v29, v29
    v_exp_f32 v30, v30
    v_exp_f32 v31, v31
    v_exp_f32 v32, v32
    v_exp_f32 v33, v33
    v_smfmac_f32_32x32x32_bf16 v[80:95], v[156:159], v[24:31], v168
    s_waitcnt lgkmcnt(0)
    ds_read_b128 v[152:155], v138 offset:3328
    ds_read_b128 v[156:159], v138 offset:3648
    v_exp_f32 v34, v34
    v_exp_f32 v35, v35
    v_exp_f32 v36, v36
    v_exp_f32 v37, v37
    v_mfma_f32_32x32x4_2b_bf16 v[0:31], v[150:151], v[136:137], v[96:127] cbsz:1 abid:0
    v_exp_f32 v38, v38
    v_exp_f32 v39, v39
    v_exp_f32 v40, v40
    v_exp_f32 v41, v41
    v_exp_f32 v42, v42
    v_exp_f32 v43, v43
    v_exp_f32 v44, v44
    v_exp_f32 v45, v45
    v_smfmac_f32_32x32x32_bf16 v[64:79], v[160:163], v[32:39], v168
    ds_read_b128 v[144:147], v169 offset:11776
    v_exp_f32 v46, v46
    v_exp_f32 v47, v47
    v_exp_f32 v48, v48
    v_exp_f32 v49, v49
    v_smfmac_f32_32x32x32_bf16 v[64:79], v[164:167], v[40:47], v168
    s_mov_b32 s41, 10240
    v_exp_f32 v50, v50
    v_exp_f32 v51, v51
    v_exp_f32 v52, v52
    v_exp_f32 v53, v53
    v_mfma_f32_32x32x16_bf16 v[0:15], v[140:143], v[128:131], v[0:15]
    v_exp_f32 v54, v54
    v_exp_f32 v55, v55
    v_exp_f32 v56, v56
    v_mfma_f32_32x32x16_bf16 v[16:31], v[140:143], v[132:135], v[16:31]
    v_exp_f32 v57, v57
    v_exp_f32 v58, v58
    v_exp_f32 v59, v59
    v_exp_f32 v60, v60
    v_smfmac_f32_32x32x32_bf16 v[80:95], v[160:163], v[48:55], v168
    v_exp_f32 v61, v61
    v_exp_f32 v62, v62
    v_exp_f32 v63, v63
    v_exp_f32 v0, v0
    v_exp_f32 v1, v1
    v_smfmac_f32_32x32x32_bf16 v[80:95], v[164:167], v[56:63], v168
    s_waitcnt lgkmcnt(0)
    ds_read_b128 v[160:163], v138 offset:3968
    ds_read_b128 v[164:167], v138 offset:4288
    v_exp_f32 v2, v2
    v_exp_f32 v3, v3
    v_exp_f32 v4, v4
    v_exp_f32 v5, v5
    v_mfma_f32_32x32x4_2b_bf16 v[32:63], v[150:151], v[136:137], v[96:127] cbsz:1 abid:1
    v_exp_f32 v6, v6
    v_exp_f32 v7, v7
    v_exp_f32 v8, v8
    v_exp_f32 v9, v9
    v_exp_f32 v10, v10
    v_exp_f32 v11, v11
    v_exp_f32 v12, v12
    v_exp_f32 v13, v13
    v_mad_i32_i24 v138, v139, s41, v138
    v_smfmac_f32_32x32x32_bf16 v[64:79], v[152:155], v[0:7], v168
    ds_read_b128 v[140:143], v169 offset:20480
    ds_read_b128 v[172:175], v169 offset:25088
    v_exp_f32 v14, v14
    v_exp_f32 v15, v15
    v_exp_f32 v16, v16
    v_exp_f32 v17, v17
    v_smfmac_f32_32x32x32_bf16 v[64:79], v[156:159], v[8:15], v168
    v_exp_f32 v18, v18
    v_exp_f32 v19, v19
    v_exp_f32 v20, v20
    v_exp_f32 v21, v21
    v_mfma_f32_32x32x16_bf16 v[32:47], v[144:147], v[128:131], v[32:47]
    v_exp_f32 v22, v22
    v_exp_f32 v23, v23
    v_exp_f32 v24, v24
    v_mfma_f32_32x32x16_bf16 v[48:63], v[144:147], v[132:135], v[48:63]
    v_exp_f32 v25, v25
    v_exp_f32 v26, v26
    v_exp_f32 v27, v27
    v_exp_f32 v28, v28
    v_smfmac_f32_32x32x32_bf16 v[80:95], v[152:155], v[16:23], v168
    v_exp_f32 v29, v29
    v_exp_f32 v30, v30
    v_exp_f32 v31, v31
    v_exp_f32 v32, v32
    v_exp_f32 v33, v33
    v_smfmac_f32_32x32x32_bf16 v[80:95], v[156:159], v[24:31], v168
    s_waitcnt lgkmcnt(0)
    ds_read_b128 v[152:155], v138 offset:2048
    ds_read_b128 v[156:159], v138 offset:2368
    v_exp_f32 v34, v34
    v_exp_f32 v35, v35
    v_exp_f32 v36, v36
    v_exp_f32 v37, v37
    v_mfma_f32_32x32x4_2b_bf16 v[0:31], v[172:173], v[136:137], v[96:127] cbsz:1 abid:0
    v_exp_f32 v38, v38
    v_exp_f32 v39, v39
    v_exp_f32 v40, v40
    v_exp_f32 v41, v41
    v_exp_f32 v42, v42
    v_exp_f32 v43, v43
    v_exp_f32 v44, v44
    v_exp_f32 v45, v45
    v_smfmac_f32_32x32x32_bf16 v[64:79], v[160:163], v[32:39], v168
    ds_read_b128 v[144:147], v169 offset:20992
    v_exp_f32 v46, v46
    v_exp_f32 v47, v47
    v_exp_f32 v48, v48
    v_exp_f32 v49, v49
    v_smfmac_f32_32x32x32_bf16 v[64:79], v[164:167], v[40:47], v168
    v_exp_f32 v50, v50
    v_exp_f32 v51, v51
    v_exp_f32 v52, v52
    v_exp_f32 v53, v53
    v_mfma_f32_32x32x16_bf16 v[0:15], v[140:143], v[128:131], v[0:15]
    v_exp_f32 v54, v54
    v_exp_f32 v55, v55
    v_exp_f32 v56, v56
    v_mfma_f32_32x32x16_bf16 v[16:31], v[140:143], v[132:135], v[16:31]
    v_exp_f32 v57, v57
    v_exp_f32 v58, v58
    v_exp_f32 v59, v59
    v_exp_f32 v60, v60
    v_smfmac_f32_32x32x32_bf16 v[80:95], v[160:163], v[48:55], v168
    v_exp_f32 v61, v61
    v_exp_f32 v62, v62
    v_exp_f32 v63, v63
    v_exp_f32 v0, v0
    v_exp_f32 v1, v1
    v_smfmac_f32_32x32x32_bf16 v[80:95], v[164:167], v[56:63], v168
    s_waitcnt lgkmcnt(0)
    ds_read_b128 v[160:163], v138 offset:2688
    ds_read_b128 v[164:167], v138 offset:3008
    v_exp_f32 v2, v2
    v_exp_f32 v3, v3
    v_exp_f32 v4, v4
    v_exp_f32 v5, v5
    v_mfma_f32_32x32x4_2b_bf16 v[32:63], v[172:173], v[136:137], v[96:127] cbsz:1 abid:1
    v_exp_f32 v6, v6
    v_exp_f32 v7, v7
    v_exp_f32 v8, v8
    v_exp_f32 v9, v9
    v_exp_f32 v10, v10
    v_exp_f32 v11, v11
    v_exp_f32 v12, v12
    v_exp_f32 v13, v13
    v_smfmac_f32_32x32x32_bf16 v[64:79], v[152:155], v[0:7], v168
    ds_read_b128 v[140:143], v169 offset:21504
    v_exp_f32 v14, v14
    v_exp_f32 v15, v15
    v_exp_f32 v16, v16
    v_exp_f32 v17, v17
    v_smfmac_f32_32x32x32_bf16 v[64:79], v[156:159], v[8:15], v168
    v_exp_f32 v18, v18
    v_exp_f32 v19, v19
    v_exp_f32 v20, v20
    v_exp_f32 v21, v21
    v_mfma_f32_32x32x16_bf16 v[32:47], v[144:147], v[128:131], v[32:47]
    v_exp_f32 v22, v22
    v_exp_f32 v23, v23
    v_exp_f32 v24, v24
    v_mfma_f32_32x32x16_bf16 v[48:63], v[144:147], v[132:135], v[48:63]
    v_exp_f32 v25, v25
    v_exp_f32 v26, v26
    v_exp_f32 v27, v27
    v_exp_f32 v28, v28
    v_smfmac_f32_32x32x32_bf16 v[80:95], v[152:155], v[16:23], v168
    v_exp_f32 v29, v29
    v_exp_f32 v30, v30
    v_exp_f32 v31, v31
    v_exp_f32 v32, v32
    v_exp_f32 v33, v33
    v_smfmac_f32_32x32x32_bf16 v[80:95], v[156:159], v[24:31], v168
    s_waitcnt lgkmcnt(0)
    ds_read_b128 v[152:155], v138 offset:3328
    ds_read_b128 v[156:159], v138 offset:3648
    v_exp_f32 v34, v34
    v_exp_f32 v35, v35
    v_exp_f32 v36, v36
    v_exp_f32 v37, v37
    v_mfma_f32_32x32x4_2b_bf16 v[0:31], v[174:175], v[136:137], v[96:127] cbsz:1 abid:0
    v_exp_f32 v38, v38
    v_exp_f32 v39, v39
    v_exp_f32 v40, v40
    v_exp_f32 v41, v41
    v_exp_f32 v42, v42
    v_exp_f32 v43, v43
    v_exp_f32 v44, v44
    v_exp_f32 v45, v45
    v_smfmac_f32_32x32x32_bf16 v[64:79], v[160:163], v[32:39], v168
    ds_read_b128 v[144:147], v169 offset:22016
    v_exp_f32 v46, v46
    v_exp_f32 v47, v47
    v_exp_f32 v48, v48
    v_exp_f32 v49, v49
    v_smfmac_f32_32x32x32_bf16 v[64:79], v[164:167], v[40:47], v168
    s_mov_b32 s41, 10240
    v_exp_f32 v50, v50
    v_exp_f32 v51, v51
    v_exp_f32 v52, v52
    v_exp_f32 v53, v53
    v_mfma_f32_32x32x16_bf16 v[0:15], v[140:143], v[128:131], v[0:15]
    v_exp_f32 v54, v54
    v_exp_f32 v55, v55
    v_exp_f32 v56, v56
    v_mfma_f32_32x32x16_bf16 v[16:31], v[140:143], v[132:135], v[16:31]
    v_exp_f32 v57, v57
    v_exp_f32 v58, v58
    v_exp_f32 v59, v59
    v_exp_f32 v60, v60
    v_smfmac_f32_32x32x32_bf16 v[80:95], v[160:163], v[48:55], v168
    v_exp_f32 v61, v61
    v_exp_f32 v62, v62
    v_exp_f32 v63, v63
    v_exp_f32 v0, v0
    v_exp_f32 v1, v1
    v_smfmac_f32_32x32x32_bf16 v[80:95], v[164:167], v[56:63], v168
    s_waitcnt lgkmcnt(0)
    ds_read_b128 v[160:163], v138 offset:3968
    ds_read_b128 v[164:167], v138 offset:4288
    v_exp_f32 v2, v2
    v_exp_f32 v3, v3
    v_exp_f32 v4, v4
    v_exp_f32 v5, v5
    v_mfma_f32_32x32x4_2b_bf16 v[32:63], v[174:175], v[136:137], v[96:127] cbsz:1 abid:1
    v_exp_f32 v6, v6
    v_exp_f32 v7, v7
    v_exp_f32 v8, v8
    v_exp_f32 v9, v9
    v_exp_f32 v10, v10
    v_exp_f32 v11, v11
    v_exp_f32 v12, v12
    v_exp_f32 v13, v13
    v_mad_i32_i24 v138, v139, s41, v138
    v_smfmac_f32_32x32x32_bf16 v[64:79], v[152:155], v[0:7], v168
    ds_read_b128 v[140:143], v169 offset:30720
    ds_read_b128 v[148:151], v169 offset:35328
    v_exp_f32 v14, v14
    v_exp_f32 v15, v15
    v_exp_f32 v16, v16
    v_exp_f32 v17, v17
    v_smfmac_f32_32x32x32_bf16 v[64:79], v[156:159], v[8:15], v168
    v_exp_f32 v18, v18
    v_exp_f32 v19, v19
    v_exp_f32 v20, v20
    v_exp_f32 v21, v21
    v_mfma_f32_32x32x16_bf16 v[32:47], v[144:147], v[128:131], v[32:47]
    v_exp_f32 v22, v22
    v_exp_f32 v23, v23
    v_exp_f32 v24, v24
    v_mfma_f32_32x32x16_bf16 v[48:63], v[144:147], v[132:135], v[48:63]
    v_exp_f32 v25, v25
    v_exp_f32 v26, v26
    v_exp_f32 v27, v27
    v_exp_f32 v28, v28
    v_smfmac_f32_32x32x32_bf16 v[80:95], v[152:155], v[16:23], v168
    v_exp_f32 v29, v29
    v_exp_f32 v30, v30
    v_exp_f32 v31, v31
    v_exp_f32 v32, v32
    v_exp_f32 v33, v33
    v_smfmac_f32_32x32x32_bf16 v[80:95], v[156:159], v[24:31], v168
    s_waitcnt lgkmcnt(0)
    ds_read_b128 v[152:155], v138 offset:2048
    ds_read_b128 v[156:159], v138 offset:2368
    v_exp_f32 v34, v34
    v_exp_f32 v35, v35
    v_exp_f32 v36, v36
    v_exp_f32 v37, v37
    v_mfma_f32_32x32x4_2b_bf16 v[0:31], v[148:149], v[136:137], v[96:127] cbsz:1 abid:0
    v_exp_f32 v38, v38
    v_exp_f32 v39, v39
    v_exp_f32 v40, v40
    v_exp_f32 v41, v41
    v_exp_f32 v42, v42
    v_exp_f32 v43, v43
    v_exp_f32 v44, v44
    v_exp_f32 v45, v45
    v_smfmac_f32_32x32x32_bf16 v[64:79], v[160:163], v[32:39], v168
    ds_read_b128 v[144:147], v169 offset:31232
    v_exp_f32 v46, v46
    v_exp_f32 v47, v47
    v_exp_f32 v48, v48
    v_exp_f32 v49, v49
    v_smfmac_f32_32x32x32_bf16 v[64:79], v[164:167], v[40:47], v168
    v_exp_f32 v50, v50
    v_exp_f32 v51, v51
    v_exp_f32 v52, v52
    v_exp_f32 v53, v53
    v_mfma_f32_32x32x16_bf16 v[0:15], v[140:143], v[128:131], v[0:15]
    v_exp_f32 v54, v54
    v_exp_f32 v55, v55
    v_exp_f32 v56, v56
    v_mfma_f32_32x32x16_bf16 v[16:31], v[140:143], v[132:135], v[16:31]
    v_exp_f32 v57, v57
    v_exp_f32 v58, v58
    v_exp_f32 v59, v59
    v_exp_f32 v60, v60
    v_smfmac_f32_32x32x32_bf16 v[80:95], v[160:163], v[48:55], v168
    v_exp_f32 v61, v61
    v_exp_f32 v62, v62
    v_exp_f32 v63, v63
    v_exp_f32 v0, v0
    v_exp_f32 v1, v1
    v_smfmac_f32_32x32x32_bf16 v[80:95], v[164:167], v[56:63], v168
    s_waitcnt lgkmcnt(0)
    ds_read_b128 v[160:163], v138 offset:2688
    ds_read_b128 v[164:167], v138 offset:3008
    v_exp_f32 v2, v2
    v_exp_f32 v3, v3
    v_exp_f32 v4, v4
    v_exp_f32 v5, v5
    v_mfma_f32_32x32x4_2b_bf16 v[32:63], v[148:149], v[136:137], v[96:127] cbsz:1 abid:1
    v_exp_f32 v6, v6
    v_exp_f32 v7, v7
    v_exp_f32 v8, v8
    v_exp_f32 v9, v9
    v_exp_f32 v10, v10
    v_exp_f32 v11, v11
    v_exp_f32 v12, v12
    v_exp_f32 v13, v13
    v_smfmac_f32_32x32x32_bf16 v[64:79], v[152:155], v[0:7], v168
    ds_read_b128 v[140:143], v169 offset:31744
    buffer_load_dword v228, v229, s[20:23], 0 offen sc1
    v_exp_f32 v14, v14
    v_exp_f32 v15, v15
    v_exp_f32 v16, v16
    v_exp_f32 v17, v17
    v_smfmac_f32_32x32x32_bf16 v[64:79], v[156:159], v[8:15], v168
    v_exp_f32 v18, v18
    v_exp_f32 v19, v19
    v_exp_f32 v20, v20
    v_exp_f32 v21, v21
    v_mfma_f32_32x32x16_bf16 v[32:47], v[144:147], v[128:131], v[32:47]
    v_exp_f32 v22, v22
    v_exp_f32 v23, v23
    v_exp_f32 v24, v24
    v_mfma_f32_32x32x16_bf16 v[48:63], v[144:147], v[132:135], v[48:63]
    v_exp_f32 v25, v25
    v_exp_f32 v26, v26
    v_exp_f32 v27, v27
    v_exp_f32 v28, v28
    v_smfmac_f32_32x32x32_bf16 v[80:95], v[152:155], v[16:23], v168
    v_exp_f32 v29, v29
    v_exp_f32 v30, v30
    v_exp_f32 v31, v31
    v_exp_f32 v32, v32
    v_exp_f32 v33, v33
    v_smfmac_f32_32x32x32_bf16 v[80:95], v[156:159], v[24:31], v168
    s_waitcnt lgkmcnt(0)
    ds_read_b128 v[152:155], v138 offset:3328
    ds_read_b128 v[156:159], v138 offset:3648
    v_exp_f32 v34, v34
    v_exp_f32 v35, v35
    v_exp_f32 v36, v36
    v_exp_f32 v37, v37
    v_mfma_f32_32x32x4_2b_bf16 v[0:31], v[150:151], v[136:137], v[96:127] cbsz:1 abid:0
    v_exp_f32 v38, v38
    v_exp_f32 v39, v39
    v_exp_f32 v40, v40
    v_exp_f32 v41, v41
    v_exp_f32 v42, v42
    v_exp_f32 v43, v43
    v_exp_f32 v44, v44
    v_exp_f32 v45, v45
    v_smfmac_f32_32x32x32_bf16 v[64:79], v[160:163], v[32:39], v168
    ds_read_b128 v[144:147], v169 offset:32256
    v_exp_f32 v46, v46
    v_exp_f32 v47, v47
    v_exp_f32 v48, v48
    v_exp_f32 v49, v49
    v_smfmac_f32_32x32x32_bf16 v[64:79], v[164:167], v[40:47], v168
    s_mov_b32 s41, -153600
    v_exp_f32 v50, v50
    v_exp_f32 v51, v51
    v_exp_f32 v52, v52
    v_exp_f32 v53, v53
    v_mfma_f32_32x32x16_bf16 v[0:15], v[140:143], v[128:131], v[0:15]
    v_exp_f32 v54, v54
    v_exp_f32 v55, v55
    v_exp_f32 v56, v56
    v_mfma_f32_32x32x16_bf16 v[16:31], v[140:143], v[132:135], v[16:31]
    v_exp_f32 v57, v57
    v_exp_f32 v58, v58
    v_exp_f32 v59, v59
    v_exp_f32 v60, v60
    v_smfmac_f32_32x32x32_bf16 v[80:95], v[160:163], v[48:55], v168
    v_exp_f32 v61, v61
    v_exp_f32 v62, v62
    v_exp_f32 v63, v63
    v_exp_f32 v0, v0
    v_exp_f32 v1, v1
    v_smfmac_f32_32x32x32_bf16 v[80:95], v[164:167], v[56:63], v168
    s_waitcnt lgkmcnt(0)
    ds_read_b128 v[160:163], v138 offset:3968
    ds_read_b128 v[164:167], v138 offset:4288
    v_exp_f32 v2, v2
    v_exp_f32 v3, v3
    v_exp_f32 v4, v4
    v_exp_f32 v5, v5
    v_mfma_f32_32x32x4_2b_bf16 v[32:63], v[150:151], v[136:137], v[96:127] cbsz:1 abid:1
    v_exp_f32 v6, v6
    v_exp_f32 v7, v7
    v_exp_f32 v8, v8
    v_exp_f32 v9, v9
    v_exp_f32 v10, v10
    v_exp_f32 v11, v11
    v_exp_f32 v12, v12
    v_exp_f32 v13, v13
    v_mad_i32_i24 v138, v139, s41, v138
    v_add_u32 v169, 4294844416, v169
    v_smfmac_f32_32x32x32_bf16 v[64:79], v[152:155], v[0:7], v168
    ds_read_b128 v[140:143], v169 offset:0
    ds_read_b128 v[172:175], v169 offset:4608
    v_exp_f32 v14, v14
    v_exp_f32 v15, v15
    v_exp_f32 v16, v16
    v_exp_f32 v17, v17
    v_smfmac_f32_32x32x32_bf16 v[64:79], v[156:159], v[8:15], v168
    v_exp_f32 v18, v18
    v_exp_f32 v19, v19
    v_exp_f32 v20, v20
    v_exp_f32 v21, v21
    v_mfma_f32_32x32x16_bf16 v[32:47], v[144:147], v[128:131], v[32:47]
    v_exp_f32 v22, v22
    v_exp_f32 v23, v23
    v_exp_f32 v24, v24
    v_mfma_f32_32x32x16_bf16 v[48:63], v[144:147], v[132:135], v[48:63]
    v_exp_f32 v25, v25
    v_exp_f32 v26, v26
    v_exp_f32 v27, v27
    v_exp_f32 v28, v28
    v_smfmac_f32_32x32x32_bf16 v[80:95], v[152:155], v[16:23], v168
    v_exp_f32 v29, v29
    v_exp_f32 v30, v30
    v_exp_f32 v31, v31
    v_exp_f32 v32, v32
    v_exp_f32 v33, v33
    v_smfmac_f32_32x32x32_bf16 v[80:95], v[156:159], v[24:31], v168
    s_waitcnt lgkmcnt(0)
    ds_read_b128 v[152:155], v138 offset:2048
    ds_read_b128 v[156:159], v138 offset:2368
    v_exp_f32 v34, v34
    v_exp_f32 v35, v35
    v_exp_f32 v36, v36
    v_exp_f32 v37, v37
    v_mfma_f32_32x32x4_2b_bf16 v[0:31], v[172:173], v[136:137], v[96:127] cbsz:1 abid:0
    v_exp_f32 v38, v38
    v_exp_f32 v39, v39
    v_exp_f32 v40, v40
    v_exp_f32 v41, v41
    v_exp_f32 v42, v42
    v_exp_f32 v43, v43
    v_exp_f32 v44, v44
    v_exp_f32 v45, v45
    v_smfmac_f32_32x32x32_bf16 v[64:79], v[160:163], v[32:39], v168
    ds_read_b128 v[144:147], v169 offset:512
    v_exp_f32 v46, v46
    v_exp_f32 v47, v47
    v_exp_f32 v48, v48
    v_exp_f32 v49, v49
    v_smfmac_f32_32x32x32_bf16 v[64:79], v[164:167], v[40:47], v168
    v_exp_f32 v50, v50
    v_exp_f32 v51, v51
    v_exp_f32 v52, v52
    v_exp_f32 v53, v53
    v_mfma_f32_32x32x16_bf16 v[0:15], v[140:143], v[128:131], v[0:15]
    v_exp_f32 v54, v54
    v_exp_f32 v55, v55
    v_exp_f32 v56, v56
    v_mfma_f32_32x32x16_bf16 v[16:31], v[140:143], v[132:135], v[16:31]
    v_exp_f32 v57, v57
    v_exp_f32 v58, v58
    v_exp_f32 v59, v59
    v_exp_f32 v60, v60
    v_smfmac_f32_32x32x32_bf16 v[80:95], v[160:163], v[48:55], v168
    v_exp_f32 v61, v61
    v_exp_f32 v62, v62
    v_exp_f32 v63, v63
    v_exp_f32 v0, v0
    v_exp_f32 v1, v1
    v_smfmac_f32_32x32x32_bf16 v[80:95], v[164:167], v[56:63], v168
    s_waitcnt lgkmcnt(0)
    ds_read_b128 v[160:163], v138 offset:2688
    ds_read_b128 v[164:167], v138 offset:3008
    v_exp_f32 v2, v2
    v_exp_f32 v3, v3
    v_exp_f32 v4, v4
    v_exp_f32 v5, v5
    v_mfma_f32_32x32x4_2b_bf16 v[32:63], v[172:173], v[136:137], v[96:127] cbsz:1 abid:1
    v_exp_f32 v6, v6
    v_exp_f32 v7, v7
    v_exp_f32 v8, v8
    v_exp_f32 v9, v9
    v_exp_f32 v10, v10
    v_exp_f32 v11, v11
    v_exp_f32 v12, v12
    v_exp_f32 v13, v13
    v_smfmac_f32_32x32x32_bf16 v[64:79], v[152:155], v[0:7], v168
    ds_read_b128 v[140:143], v169 offset:1024
    v_exp_f32 v14, v14
    v_exp_f32 v15, v15
    v_exp_f32 v16, v16
    v_exp_f32 v17, v17
    v_smfmac_f32_32x32x32_bf16 v[64:79], v[156:159], v[8:15], v168
    v_exp_f32 v18, v18
    v_exp_f32 v19, v19
    v_exp_f32 v20, v20
    v_exp_f32 v21, v21
    v_mfma_f32_32x32x16_bf16 v[32:47], v[144:147], v[128:131], v[32:47]
    v_exp_f32 v22, v22
    v_exp_f32 v23, v23
    v_exp_f32 v24, v24
    v_mfma_f32_32x32x16_bf16 v[48:63], v[144:147], v[132:135], v[48:63]
a_pad3:
    s_cmp_eq_u32 s37, 2
    s_cbranch_scc1 a_back3
    v_exp_f32 v25, v25
    v_exp_f32 v26, v26
    v_exp_f32 v27, v27
    v_exp_f32 v28, v28
    v_smfmac_f32_32x32x32_bf16 v[80:95], v[152:155], v[16:23], v168
    v_exp_f32 v29, v29
    v_exp_f32 v30, v30
    v_exp_f32 v31, v31
    v_exp_f32 v32, v32
    v_exp_f32 v33, v33
    v_smfmac_f32_32x32x32_bf16 v[80:95], v[156:159], v[24:31], v168
    s_waitcnt lgkmcnt(0)
    ds_read_b128 v[152:155], v138 offset:3328
    ds_read_b128 v[156:159], v138 offset:3648
    v_exp_f32 v34, v34
    v_exp_f32 v35, v35
    v_exp_f32 v36, v36
    v_exp_f32 v37, v37
    v_mfma_f32_32x32x4_2b_bf16 v[0:31], v[174:175], v[136:137], v[96:127] cbsz:1 abid:0
    v_exp_f32 v38, v38
    v_exp_f32 v39, v39
    v_exp_f32 v40, v40
    v_exp_f32 v41, v41
    v_exp_f32 v42, v42
    v_exp_f32 v43, v43
    v_exp_f32 v44, v44
    v_exp_f32 v45, v45
    v_smfmac_f32_32x32x32_bf16 v[64:79], v[160:163], v[32:39], v168
    ds_read_b128 v[144:147], v169 offset:1536
    v_exp_f32 v46, v46
    v_exp_f32 v47, v47
    v_exp_f32 v48, v48
    v_exp_f32 v49, v49
    v_smfmac_f32_32x32x32_bf16 v[64:79], v[164:167], v[40:47], v168
    v_exp_f32 v50, v50
    v_exp_f32 v51, v51
    v_exp_f32 v52, v52
    v_exp_f32 v53, v53
    v_mfma_f32_32x32x16_bf16 v[0:15], v[140:143], v[128:131], v[0:15]
    v_exp_f32 v54, v54
    v_exp_f32 v55, v55
    v_exp_f32 v56, v56
    v_mfma_f32_32x32x16_bf16 v[16:31], v[140:143], v[132:135], v[16:31]
    v_exp_f32 v57, v57
    v_exp_f32 v58, v58
    v_exp_f32 v59, v59
    v_exp_f32 v60, v60
    v_smfmac_f32_32x32x32_bf16 v[80:95], v[160:163], v[48:55], v168
    v_exp_f32 v61, v61
    v_exp_f32 v62, v62
    v_exp_f32 v63, v63
    v_exp_f32 v0, v0
    v_exp_f32 v1, v1
    v_smfmac_f32_32x32x32_bf16 v[80:95], v[164:167], v[56:63], v168
    s_waitcnt lgkmcnt(0)
    ds_read_b128 v[160:163], v138 offset:3968
    ds_read_b128 v[164:167], v138 offset:4288
    v_exp_f32 v2, v2
    v_exp_f32 v3, v3
    v_exp_f32 v4, v4
    v_exp_f32 v5, v5
    v_mfma_f32_32x32x4_2b_bf16 v[32:63], v[174:175], v[136:137], v[96:127] cbsz:1 abid:1
    v_exp_f32 v6, v6
    v_exp_f32 v7, v7
    v_exp_f32 v8, v8
    v_exp_f32 v9, v9
    v_exp_f32 v10, v10
    v_exp_f32 v11, v11
    v_exp_f32 v12, v12
    v_exp_f32 v13, v13
    v_smfmac_f32_32x32x32_bf16 v[64:79], v[152:155], v[0:7], v168
    v_exp_f32 v14, v14
    v_exp_f32 v15, v15
    v_exp_f32 v16, v16
    v_exp_f32 v17, v17
    v_smfmac_f32_32x32x32_bf16 v[64:79], v[156:159], v[8:15], v168
    v_exp_f32 v18, v18
    v_exp_f32 v19, v19
    v_exp_f32 v20, v20
    v_exp_f32 v21, v21
    v_mfma_f32_32x32x16_bf16 v[32:47], v[144:147], v[128:131], v[32:47]
    v_exp_f32 v22, v22
    v_exp_f32 v23, v23
    v_exp_f32 v24, v24
    v_mfma_f32_32x32x16_bf16 v[48:63], v[144:147], v[132:135], v[48:63]
    v_exp_f32 v25, v25
    v_exp_f32 v26, v26
    v_exp_f32 v27, v27
    v_exp_f32 v28, v28
    v_smfmac_f32_32x32x32_bf16 v[80:95], v[152:155], v[16:23], v168
    v_exp_f32 v29, v29
    v_exp_f32 v30, v30
    v_exp_f32 v31, v31
    v_exp_f32 v32, v32
    v_exp_f32 v33, v33
    v_smfmac_f32_32x32x32_bf16 v[80:95], v[156:159], v[24:31], v168
    s_waitcnt vmcnt(0) lgkmcnt(0)
    s_barrier
    v_exp_f32 v34, v34
    v_exp_f32 v35, v35
    v_exp_f32 v36, v36
    v_exp_f32 v37, v37
    v_exp_f32 v38, v38
    v_exp_f32 v39, v39
    v_exp_f32 v40, v40
    v_exp_f32 v41, v41
    v_smfmac_f32_32x32x32_bf16 v[64:79], v[160:163], v[32:39], v168
    s_mov_b32 s42, 0x0c800000
    s_mov_b32 s41, 0x7b800000
    v_exp_f32 v42, v42
    v_exp_f32 v43, v43
    v_exp_f32 v44, v44
    v_exp_f32 v45, v45
    v_exp_f32 v46, v46
    v_exp_f32 v47, v47
    v_exp_f32 v48, v48
    v_exp_f32 v49, v49
    v_smfmac_f32_32x32x32_bf16 v[64:79], v[164:167], v[40:47], v168
    s_mov_b32 s43, 2038431744
    s_mov_b32 s44, s37
    v_exp_f32 v50, v50
    v_exp_f32 v51, v51
    v_exp_f32 v52, v52
    v_exp_f32 v53, v53
    v_exp_f32 v54, v54
    v_exp_f32 v55, v55
    v_exp_f32 v56, v56
    v_exp_f32 v57, v57
    v_smfmac_f32_32x32x32_bf16 v[80:95], v[160:163], v[48:55], v168
    v_readfirstlane_b32 s63, v211
    v_mov_b32 v204, v72
    v_mov_b32 v205, v72
    s_nop 1
    v_permlane32_swap_b32 v204, v205
    v_rcp_f32 v204, v205
    v_cmp_nge_f32 vcc, v205, s42
    v_cmp_nle_f32 s[50:51], v205, s41
    v_mul_f32 v204, v204, v228
    v_maximum3_f32 v205, |v64|, |v65|, |v66|
    s_or_b64 s[50:51], s[50:51], vcc
    v_maximum3_f32 v205, v205, |v67|, |v68|
    v_maximum3_f32 v205, v205, |v69|, |v70|
    v_maximum3_f32 v205, v205, |v71|, |v72|
    v_maximum3_f32 v205, v205, |v73|, |v74|
    v_maximum3_f32 v205, v205, |v75|, |v75|
    v_subrev_u32 v205, 100663296, v205
    v_cmp_le_u32 vcc, s43, v205
    v_pk_mul_f32 v[64:65], v[64:65], v[204:205] op_sel_hi:[1,0]
    v_pk_mul_f32 v[66:67], v[66:67], v[204:205] op_sel_hi:[1,0]
    v_pk_mul_f32 v[68:69], v[68:69], v[204:205] op_sel_hi:[1,0]
    v_pk_mul_f32 v[70:71], v[70:71], v[204:205] op_sel_hi:[1,0]
    v_pk_mul_f32 v[72:73], v[72:73], v[204:205] op_sel_hi:[1,0]
    v_pk_mul_f32 v[74:75], v[74:75], v[204:205] op_sel_hi:[1,0]
    v_cvt_pk_bf16_f32 v172, v64, v65
    v_cvt_pk_bf16_f32 v173, v66, v67
    v_cvt_pk_bf16_f32 v174, v68, v69
    v_cvt_pk_bf16_f32 v175, v70, v71
    s_or_b64 s[50:51], s[50:51], vcc
    s_cbranch_scc1 t_bad0
t_st0:
    s_cmp_eq_u32 s63, 0
    s_cbranch_scc1 t_far0
    buffer_store_dwordx4 v[172:175], v170, s[68:71], s48 offen
t_nst0:
    v_cvt_pk_bf16_f32 v180, v72, v73
    v_cvt_pk_bf16_f32 v181, v74, v75
    v_exp_f32 v58, v58
    v_exp_f32 v59, v59
    v_exp_f32 v60, v60
    v_exp_f32 v61, v61
    v_exp_f32 v62, v62
    v_exp_f32 v63, v63
    s_nop 1
    v_smfmac_f32_32x32x32_bf16 v[80:95], v[164:167], v[56:63], v168
    s_mul_i32 s40, s62, 10240
    s_add_u32 s40, s40, 4294875136
    v_add_u32 v209, s40, v202
    v_add_u32 v210, 61440, v209
    s_nop 7
    v_mov_b32 v204, v88
    v_mov_b32 v205, v88
    s_nop 1
    v_permlane32_swap_b32 v204, v205
    v_rcp_f32 v204, v205
    v_cmp_nge_f32 vcc, v205, s42
    v_cmp_nle_f32 s[50:51], v205, s41
    v_mul_f32 v204, v204, v228
    v_maximum3_f32 v205, |v80|, |v81|, |v82|
    s_or_b64 s[50:51], s[50:51], vcc
    v_maximum3_f32 v205, v205, |v83|, |v84|
    v_maximum3_f32 v205, v205, |v85|, |v86|
    v_maximum3_f32 v205, v205, |v87|, |v88|
    v_maximum3_f32 v205, v205, |v89|, |v90|
    v_maximum3_f32 v205, v205, |v91|, |v91|
    v_subrev_u32 v205, 100663296, v205
    v_cmp_le_u32 vcc, s43, v205
    v_pk_mul_f32 v[80:81], v[80:81], v[204:205] op_sel_hi:[1,0]
    v_pk_mul_f32 v[82:83], v[82:83], v[204:205] op_sel_hi:[1,0]
    v_pk_mul_f32 v[84:85], v[84:85], v[204:205] op_sel_hi:[1,0]
    v_pk_mul_f32 v[86:87], v[86:87], v[204:205] op_sel_hi:[1,0]
    v_pk_mul_f32 v[88:89], v[88:89], v[204:205] op_sel_hi:[1,0]
    v_pk_mul_f32 v[90:91], v[90:91], v[204:205] op_sel_hi:[1,0]
    v_cvt_pk_bf16_f32 v176, v80, v81
    v_cvt_pk_bf16_f32 v177, v82, v83
    v_cvt_pk_bf16_f32 v178, v84, v85
    v_cvt_pk_bf16_f32 v179, v86, v87
    s_or_b64 s[50:51], s[50:51], vcc
    s_cbranch_scc1 t_bad1
t_st1:
    s_cmp_eq_u32 s63, 0
    s_cbranch_scc1 t_far1
    buffer_store_dwordx4 v[176:179], v170, s[68:71], s0 offen
t_nst1:
    v_cvt_pk_bf16_f32 v182, v88, v89
    v_cvt_pk_bf16_f32 v183, v90, v91
    s_cmp_lg_u32 s44, 0
    s_cbranch_scc1 t_bad2
t_st2:
    s_mov_b32 exec_hi, 0
    s_cmp_eq_u32 s63, 0
    s_cbranch_scc1 t_far2
    buffer_store_dwordx4 v[180:183], v200, s[68:71], s1 offen
t_nst2:
    s_mov_b32 exec_hi, -1
    s_setprio 0
    s_waitcnt lgkmcnt(0)
    s_barrier
    ds_read_b32 v212, v255 offset:32
    ds_read_b64_tr_b16 v[0:1], v209 offset:0
    ds_read_b64_tr_b16 v[2:3], v209 offset:2560
    ds_read_b64_tr_b16 v[4:5], v209 offset:32
    ds_read_b64_tr_b16 v[6:7], v209 offset:2592
    ds_read_b64_tr_b16 v[8:9], v209 offset:64
    ds_read_b64_tr_b16 v[10:11], v209 offset:2624
    ds_read_b64_tr_b16 v[12:13], v209 offset:96
    ds_read_b64_tr_b16 v[14:15], v209 offset:2656
    ds_read_b64_tr_b16 v[16:17], v209 offset:128
    ds_read_b64_tr_b16 v[18:19], v209 offset:2688
    ds_read_b64_tr_b16 v[20:21], v209 offset:5120
    ds_read_b64_tr_b16 v[22:23], v209 offset:7680
    ds_read_b64_tr_b16 v[24:25], v209 offset:5152
    ds_read_b64_tr_b16 v[26:27], v209 offset:7712
    ds_read_b64_tr_b16 v[28:29], v209 offset:5184
    ds_read_b64_tr_b16 v[30:31], v209 offset:7744
    ds_read_b64_tr_b16 v[32:33], v209 offset:5216
    ds_read_b64_tr_b16 v[34:35], v209 offset:7776
    ds_read_b64_tr_b16 v[36:37], v209 offset:5248
    ds_read_b64_tr_b16 v[38:39], v209 offset:7808
    s_mov_b32 s46, 0
    s_waitcnt lgkmcnt(15)
    v_cmp_ne_u32 vcc, 0, v212
    s_nop 0
    s_cmp_lg_u64 vcc, 0
    s_cbranch_scc1 a_exact
    v_mov_b64 v[232:233], 0
    v_mov_b64 v[234:235], 0
    v_mov_b64 v[236:237], 0
    v_mov_b64 v[238:239], 0
    v_mov_b64 v[240:241], 0
    v_mov_b64 v[242:243], 0
    v_mov_b64 v[244:245], 0
    v_mov_b64 v[246:247], 0
    v_mov_b64 v[248:249], 0
    v_mov_b64 v[250:251], 0
    ds_read_b64_tr_b16 v[40:41], v209 offset:20480
    ds_read_b64_tr_b16 v[42:43], v209 offset:23040
    ds_read_b64_tr_b16 v[44:45], v209 offset:20512
    ds_read_b64_tr_b16 v[46:47], v209 offset:23072
    ds_read_b64_tr_b16 v[48:49], v209 offset:20544
    ds_read_b64_tr_b16 v[50:51], v209 offset:23104
    ds_read_b64_tr_b16 v[52:53], v209 offset:20576
    ds_read_b64_tr_b16 v[54:55], v209 offset:23136
    ds_read_b64_tr_b16 v[56:57], v209 offset:20608
    ds_read_b64_tr_b16 v[58:59], v209 offset:23168
    ds_read_b64_tr_b16 v[60:61], v209 offset:25600
    ds_read_b64_tr_b16 v[62:63], v209 offset:28160
    ds_read_b64_tr_b16 v[64:65], v209 offset:25632
    ds_read_b64_tr_b16 v[66:67], v209 offset:28192
    ds_read_b64_tr_b16 v[68:69], v209 offset:25664
    ds_read_b64_tr_b16 v[70:71], v209 offset:28224
    ds_read_b64_tr_b16 v[72:73], v209 offset:25696
    ds_read_b64_tr_b16 v[74:75], v209 offset:28256
    ds_read_b64_tr_b16 v[76:77], v209 offset:25728
    ds_read_b64_tr_b16 v[78:79], v209 offset:28288
    ds_read_b64_tr_b16 v[80:81], v209 offset:40960
    ds_read_b64_tr_b16 v[82:83], v209 offset:43520
    ds_read_b64_tr_b16 v[84:85], v209 offset:40992
    ds_read_b64_tr_b16 v[86:87], v209 offset:43552
    ds_read_b64_tr_b16 v[88:89], v209 offset:41024
    ds_read_b64_tr_b16 v[90:91], v209 offset:43584
    ds_read_b64_tr_b16 v[92:93], v209 offset:41056
    ds_read_b64_tr_b16 v[94:95], v209 offset:43616
    ds_read_b64_tr_b16 v[96:97], v209 offset:41088
    ds_read_b64_tr_b16 v[98:99], v209 offset:43648
    ds_read_b64_tr_b16 v[100:101], v209 offset:46080
    ds_read_b64_tr_b16 v[102:103], v209 offset:48640
    ds_read_b64_tr_b16 v[104:105], v209 offset:46112
    ds_read_b64_tr_b16 v[106:107], v209 offset:48672
    ds_read_b64_tr_b16 v[108:109], v209 offset:46144
    ds_read_b64_tr_b16 v[110:111], v209 offset:48704
    ds_read_b64_tr_b16 v[112:113], v209 offset:46176
    ds_read_b64_tr_b16 v[114:115], v209 offset:48736
    ds_read_b64_tr_b16 v[116:117], v209 offset:46208
    ds_read_b64_tr_b16 v[118:119], v209 offset:48768
    ds_read_b64_tr_b16 v[160:161], v210 offset:0
    ds_read_b64_tr_b16 v[162:163], v210 offset:2560
    ds_read_b64_tr_b16 v[164:165], v210 offset:32
    ds_read_b64_tr_b16 v[166:167], v210 offset:2592
    ds_read_b64_tr_b16 v[168:169], v210 offset:64
    ds_read_b64_tr_b16 v[170:171], v210 offset:2624
    ds_read_b64_tr_b16 v[172:173], v210 offset:96
    ds_read_b64_tr_b16 v[174:175], v210 offset:2656
    ds_read_b64_tr_b16 v[176:177], v210 offset:128
    ds_read_b64_tr_b16 v[178:179], v210 offset:2688
    ds_read_b64_tr_b16 v[180:181], v210 offset:5120
    ds_read_b64_tr_b16 v[182:183], v210 offset:7680
    ds_read_b64_tr_b16 v[184:185], v210 offset:5152
    ds_read_b64_tr_b16 v[186:187], v210 offset:7712
    ds_read_b64_tr_b16 v[188:189], v210 offset:5184
    ds_read_b64_tr_b16 v[190:191], v210 offset:7744
    ds_read_b64_tr_b16 v[192:193], v210 offset:5216
    ds_read_b64_tr_b16 v[194:195], v210 offset:7776
    ds_read_b64_tr_b16 v[196:197], v210 offset:5248
    ds_read_b64_tr_b16 v[198:199], v210 offset:7808
    buffer_load_dwordx4 v[120:123], v200, s[68:71], s52 offen offset:0 sc1
    buffer_load_dwordx4 v[124:127], v200, s[68:71], s52 offen offset:1024 sc1
    buffer_load_dwordx4 v[144:147], v200, s[68:71], s53 offen offset:0 sc1
    buffer_load_dwordx4 v[148:151], v200, s[68:71], s53 offen offset:1024 sc1
    buffer_load_dwordx4 v[152:155], v200, s[68:71], s54 offen offset:0 sc1
    buffer_load_dwordx4 v[156:159], v200, s[68:71], s54 offen offset:1024 sc1
    buffer_load_dwordx4 v[136:139], v200, s[68:71], s55 offen offset:0 sc1
    buffer_load_dwordx4 v[140:143], v200, s[68:71], s55 offen offset:1024 sc1
    buffer_load_dwordx4 v[128:131], v200, s[68:71], s56 offen offset:0 sc1
    buffer_load_dwordx4 v[132:135], v200, s[68:71], s56 offen offset:1024 sc1
t_l2:
    s_waitcnt vmcnt(8)
    v_max3_u32 v204, v120, v121, v122
    v_max3_u32 v205, v123, v124, v125
    v_max3_u32 v204, v204, v126, v127
    v_max_u32 v204, v204, v205
    v_cmp_eq_u32 vcc, -1, v204
    s_waitcnt lgkmcnt(0)
t_s0:
    s_cmp_eq_u64 vcc, 0
    s_cbranch_scc0 t_r0
t_c0:
    v_mfma_f32_16x16x32_bf16 v[232:235], v[0:3], v[120:123], v[232:235]
    v_mfma_f32_16x16x32_bf16 v[236:239], v[4:7], v[120:123], v[236:239]
    v_mfma_f32_16x16x32_bf16 v[240:243], v[8:11], v[120:123], v[240:243]
    v_mfma_f32_16x16x32_bf16 v[244:247], v[12:15], v[120:123], v[244:247]
    v_mfma_f32_16x16x32_bf16 v[248:251], v[16:19], v[120:123], v[248:251]
    v_mfma_f32_16x16x32_bf16 v[232:235], v[20:23], v[124:127], v[232:235]
t_m6:
    v_mfma_f32_16x16x32_bf16 v[236:239], v[24:27], v[124:127], v[236:239]
    s_waitcnt vmcnt(6)
    v_max3_u32 v204, v144, v145, v146
    v_max3_u32 v205, v147, v148, v149
    v_mfma_f32_16x16x32_bf16 v[240:243], v[28:31], v[124:127], v[240:243]
    v_max3_u32 v204, v204, v150, v151
    v_max_u32 v204, v204, v205
    v_mfma_f32_16x16x32_bf16 v[244:247], v[32:35], v[124:127], v[244:247]
    v_cmp_eq_u32 vcc, -1, v204
    v_mfma_f32_16x16x32_bf16 v[248:251], v[36:39], v[124:127], v[248:251]
t_s1:
    s_cmp_eq_u64 vcc, 0
    s_cbranch_scc0 t_r1
t_c1:
    v_mfma_f32_16x16x32_bf16 v[232:235], v[40:43], v[144:147], v[232:235]
    ds_read_b64_tr_b16 v[0:1], v210 offset:20480
    v_mfma_f32_16x16x32_bf16 v[236:239], v[44:47], v[144:147], v[236:239]
    ds_read_b64_tr_b16 v[2:3], v210 offset:23040
    v_mfma_f32_16x16x32_bf16 v[240:243], v[48:51], v[144:147], v[240:243]
    ds_read_b64_tr_b16 v[4:5], v210 offset:20512
    v_mfma_f32_16x16x32_bf16 v[244:247], v[52:55], v[144:147], v[244:247]
    ds_read_b64_tr_b16 v[6:7], v210 offset:23072
    v_mfma_f32_16x16x32_bf16 v[248:251], v[56:59], v[144:147], v[248:251]
    ds_read_b64_tr_b16 v[8:9], v210 offset:20544
    v_mfma_f32_16x16x32_bf16 v[232:235], v[60:63], v[148:151], v[232:235]
    ds_read_b64_tr_b16 v[10:11], v210 offset:23104
    v_mfma_f32_16x16x32_bf16 v[236:239], v[64:67], v[148:151], v[236:239]
    s_waitcnt vmcnt(4)
    v_max3_u32 v204, v152, v153, v154
    v_max3_u32 v205, v155, v156, v157
    v_mfma_f32_16x16x32_bf16 v[240:243], v[68:71], v[148:151], v[240:243]
    v_max3_u32 v204, v204, v158, v159
    v_max_u32 v204, v204, v205
    v_mfma_f32_16x16x32_bf16 v[244:247], v[72:75], v[148:151], v[244:247]
    v_cmp_eq_u32 vcc, -1, v204
    v_mfma_f32_16x16x32_bf16 v[248:251], v[76:79], v[148:151], v[248:251]
t_s2:
    s_cmp_eq_u64 vcc, 0
    s_cbranch_scc0 t_r2
t_c2:
    v_mfma_f32_16x16x32_bf16 v[232:235], v[80:83], v[152:155], v[232:235]
    ds_read_b64_tr_b16 v[12:13], v210 offset:20576
    v_mfma_f32_16x16x32_bf16 v[236:239], v[84:87], v[152:155], v[236:239]
    ds_read_b64_tr_b16 v[14:15], v210 offset:23136
    v_mfma_f32_16x16x32_bf16 v[240:243], v[88:91], v[152:155], v[240:243]
    ds_read_b64_tr_b16 v[16:17], v210 offset:20608
    v_mfma_f32_16x16x32_bf16 v[244:247], v[92:95], v[152:155], v[244:247]
    ds_read_b64_tr_b16 v[18:19], v210 offset:23168
    v_mfma_f32_16x16x32_bf16 v[248:251], v[96:99], v[152:155], v[248:251]
    s_waitcnt vmcnt(0)
    v_max3_u32 v204, v136, v137, v138
    v_max3_u32 v205, v139, v140, v141
    v_mfma_f32_16x16x32_bf16 v[232:235], v[100:103], v[156:159], v[232:235]
    v_max3_u32 v204, v204, v142, v143
    v_max3_u32 v205, v205, v128, v129
    v_mfma_f32_16x16x32_bf16 v[236:239], v[104:107], v[156:159], v[236:239]
    v_max3_u32 v204, v204, v130, v131
    v_max3_u32 v205, v205, v132, v133
    v_mfma_f32_16x16x32_bf16 v[240:243], v[108:111], v[156:159], v[240:243]
    v_max3_u32 v204, v204, v134, v135
    v_max_u32 v204, v204, v205
    v_mfma_f32_16x16x32_bf16 v[244:247], v[112:115], v[156:159], v[244:247]
    v_cmp_eq_u32 vcc, -1, v204
    v_mfma_f32_16x16x32_bf16 v[248:251], v[116:119], v[156:159], v[248:251]
t_s3:
    s_cmp_eq_u64 vcc, 0
    s_cbranch_scc0 t_r3
t_c3:
    v_mfma_f32_16x16x32_bf16 v[232:235], v[160:163], v[136:139], v[232:235]
    s_cmp_eq_u32 s63, 0
    s_cbranch_scc1 t_dfar
    s_mov_b64 exec, 1
    buffer_store_dword v255, v226, s[20:23], s74 offen
t_dret:
    s_mov_b64 exec, -1
    v_mfma_f32_16x16x32_bf16 v[236:239], v[164:167], v[136:139], v[236:239]
    ds_read_b64_tr_b16 v[20:21], v210 offset:25600
    ds_read_b64_tr_b16 v[22:23], v210 offset:28160
    v_mfma_f32_16x16x32_bf16 v[240:243], v[168:171], v[136:139], v[240:243]
    ds_read_b64_tr_b16 v[24:25], v210 offset:25632
    ds_read_b64_tr_b16 v[26:27], v210 offset:28192
    v_mfma_f32_16x16x32_bf16 v[244:247], v[172:175], v[136:139], v[244:247]
    ds_read_b64_tr_b16 v[28:29], v210 offset:25664
    ds_read_b64_tr_b16 v[30:31], v210 offset:28224
    v_mfma_f32_16x16x32_bf16 v[248:251], v[176:179], v[136:139], v[248:251]
    ds_read_b64_tr_b16 v[32:33], v210 offset:25696
    ds_read_b64_tr_b16 v[34:35], v210 offset:28256
    v_mfma_f32_16x16x32_bf16 v[232:235], v[180:183], v[140:143], v[232:235]
    ds_read_b64_tr_b16 v[36:37], v210 offset:25728
    v_mfma_f32_16x16x32_bf16 v[236:239], v[184:187], v[140:143], v[236:239]
    ds_read_b64_tr_b16 v[38:39], v210 offset:28288
    v_mfma_f32_16x16x32_bf16 v[240:243], v[188:191], v[140:143], v[240:243]
    v_mfma_f32_16x16x32_bf16 v[244:247], v[192:195], v[140:143], v[244:247]
    s_cmp_eq_u32 s3, 0
    v_mfma_f32_16x16x32_bf16 v[248:251], v[196:199], v[140:143], v[248:251]
    s_waitcnt lgkmcnt(0)
    s_cbranch_scc0 t_svc
    v_mfma_f32_16x16x32_bf16 v[232:235], v[0:3], v[128:131], v[232:235]
    s_barrier
    ds_read_b128 v[40:43], v223 offset:0
    v_mfma_f32_16x16x32_bf16 v[232:235], v[20:23], v[132:135], v[232:235]
    ds_read_b128 v[44:47], v223 offset:1024
    v_mfma_f32_16x16x32_bf16 v[236:239], v[4:7], v[128:131], v[236:239]
    ds_read_b128 v[48:51], v223 offset:2048
    v_mfma_f32_16x16x32_bf16 v[236:239], v[24:27], v[132:135], v[236:239]
    ds_read_b128 v[52:55], v223 offset:3072
    v_mfma_f32_16x16x32_bf16 v[240:243], v[8:11], v[128:131], v[240:243]
    ds_read_b128 v[56:59], v223 offset:4096
    v_mfma_f32_16x16x32_bf16 v[240:243], v[28:31], v[132:135], v[240:243]
    buffer_load_dword v212, v227, s[20:23], s74 offen sc1
    v_mfma_f32_16x16x32_bf16 v[244:247], v[12:15], v[128:131], v[244:247]
    v_mfma_f32_16x16x32_bf16 v[244:247], v[32:35], v[132:135], v[244:247]
    s_waitcnt lgkmcnt(4)
    v_pk_add_f32 v[232:233], v[232:233], v[40:41]
    v_pk_add_f32 v[234:235], v[234:235], v[42:43]
    v_mfma_f32_16x16x32_bf16 v[248:251], v[16:19], v[128:131], v[248:251]
    v_cvt_pk_bf16_f32 v232, v232, v233
    v_cvt_pk_bf16_f32 v233, v234, v235
    v_mfma_f32_16x16x32_bf16 v[248:251], v[36:39], v[132:135], v[248:251]
    ds_write_b64 v222, v[232:233] offset:0
    s_waitcnt lgkmcnt(4)
    v_pk_add_f32 v[236:237], v[236:237], v[44:45]
    v_pk_add_f32 v[238:239], v[238:239], v[46:47]
    v_cvt_pk_bf16_f32 v236, v236, v237
    v_cvt_pk_bf16_f32 v237, v238, v239
    ds_write_b64 v222, v[236:237] offset:32
    s_waitcnt lgkmcnt(4)
    v_pk_add_f32 v[240:241], v[240:241], v[48:49]
    v_pk_add_f32 v[242:243], v[242:243], v[50:51]
    v_cvt_pk_bf16_f32 v240, v240, v241
    v_cvt_pk_bf16_f32 v241, v242, v243
    ds_write_b64 v222, v[240:241] offset:64
    s_waitcnt lgkmcnt(4)
    v_pk_add_f32 v[244:245], v[244:245], v[52:53]
    v_pk_add_f32 v[246:247], v[246:247], v[54:55]
    v_cvt_pk_bf16_f32 v244, v244, v245
    v_cvt_pk_bf16_f32 v245, v246, v247
    ds_write_b64 v222, v[244:245] offset:96
    s_waitcnt lgkmcnt(4)
    v_pk_add_f32 v[248:249], v[248:249], v[56:57]
    v_pk_add_f32 v[250:251], v[250:251], v[58:59]
    v_cvt_pk_bf16_f32 v248, v248, v249
    v_cvt_pk_bf16_f32 v249, v250, v251
    ds_write_b64 v222, v[248:249] offset:128
    ds_read_b128 v[0:3], v219
    ds_read_b128 v[4:7], v220
    ds_read_b128 v[8:11], v221
    s_waitcnt vmcnt(0)
    v_cmp_eq_u32 vcc, 0, v212
    s_nop 0
    s_cmp_eq_u64 vcc, 0
    s_cbranch_scc0 t_dw
t_dok:
    s_cmp_eq_u32 s63, 0
    s_cbranch_scc1 t_ofar
    s_waitcnt lgkmcnt(2)
    buffer_store_dwordx4 v[0:3], v216, s[68:71], s75 offen
    s_waitcnt lgkmcnt(1)
    buffer_store_dwordx4 v[4:7], v217, s[68:71], s75 offen
    s_waitcnt lgkmcnt(0)
    s_mov_b32 exec_hi, 0
    buffer_store_dwordx4 v[8:11], v218, s[68:71], s75 offen
t_fin:
k_end:
    s_endpgm
t_r0:
    s_add_u32 s46, s46, 1
    s_cmp_gt_u32 s46, 2000000
    s_cbranch_scc1 t_c0
    s_sleep 1
    buffer_load_dwordx4 v[120:123], v200, s[68:71], s52 offen offset:0 sc1
    buffer_load_dwordx4 v[124:127], v200, s[68:71], s52 offen offset:1024 sc1
    s_waitcnt vmcnt(0)
    v_max3_u32 v204, v120, v121, v122
    v_max3_u32 v205, v123, v124, v125
    v_max3_u32 v204, v204, v126, v127
    v_max_u32 v204, v204, v205
    v_cmp_eq_u32 vcc, -1, v204
    s_branch t_s0
t_r1:
    s_add_u32 s46, s46, 1
    s_cmp_gt_u32 s46, 2000000
    s_cbranch_scc1 t_c1
    s_sleep 1
    buffer_load_dwordx4 v[144:147], v200, s[68:71], s53 offen offset:0 sc1
    buffer_load_dwordx4 v[148:151], v200, s[68:71], s53 offen offset:1024 sc1
    s_waitcnt vmcnt(0)
    v_max3_u32 v204, v144, v145, v146
    v_max3_u32 v205, v147, v148, v149
    v_max3_u32 v204, v204, v150, v151
    v_max_u32 v204, v204, v205
    v_cmp_eq_u32 vcc, -1, v204
    s_branch t_s1
t_r2:
    s_add_u32 s46, s46, 1
    s_cmp_gt_u32 s46, 2000000
    s_cbranch_scc1 t_c2
    s_sleep 1
    buffer_load_dwordx4 v[152:155], v200, s[68:71], s54 offen offset:0 sc1
    buffer_load_dwordx4 v[156:159], v200, s[68:71], s54 offen offset:1024 sc1
    s_waitcnt vmcnt(0)
    v_max3_u32 v204, v152, v153, v154
    v_max3_u32 v205, v155, v156, v157
    v_max3_u32 v204, v204, v158, v159
    v_max_u32 v204, v204, v205
    v_cmp_eq_u32 vcc, -1, v204
    s_branch t_s2
t_r3:
    s_add_u32 s46, s46, 1
    s_cmp_gt_u32 s46, 2000000
    s_cbranch_scc1 t_c3
    s_sleep 1
    buffer_load_dwordx4 v[136:139], v200, s[68:71], s55 offen offset:0 sc1
    buffer_load_dwordx4 v[140:143], v200, s[68:71], s55 offen offset:1024 sc1
    buffer_load_dwordx4 v[128:131], v200, s[68:71], s56 offen offset:0 sc1
    buffer_load_dwordx4 v[132:135], v200, s[68:71], s56 offen offset:1024 sc1
    s_waitcnt vmcnt(0)
    v_max3_u32 v204, v136, v137, v138
    v_max3_u32 v205, v139, v140, v141
    v_max3_u32 v204, v204, v142, v143
    v_max3_u32 v205, v205, v128, v129
    v_max3_u32 v204, v204, v130, v131
    v_max3_u32 v205, v205, v132, v133
    v_max3_u32 v204, v204, v134, v135
    v_max_u32 v204, v204, v205
    v_cmp_eq_u32 vcc, -1, v204
    s_branch t_s3
t_far0:
    buffer_store_dwordx4 v[172:175], v170, s[68:71], s48 offen sc1
    s_branch t_nst0
t_far1:
    buffer_store_dwordx4 v[176:179], v170, s[68:71], s0 offen sc1
    s_branch t_nst1
t_far2:
    buffer_store_dwordx4 v[180:183], v200, s[68:71], s1 offen sc1
    s_branch t_nst2
t_ofar:
    s_waitcnt lgkmcnt(2)
    buffer_store_dwordx4 v[0:3], v216, s[68:71], s75 offen sc1
    s_waitcnt lgkmcnt(1)
    buffer_store_dwordx4 v[4:7], v217, s[68:71], s75 offen sc1
    s_waitcnt lgkmcnt(0)
    s_mov_b32 exec_hi, 0
    buffer_store_dwordx4 v[8:11], v218, s[68:71], s75 offen sc1
    s_branch t_fin
t_bad0:
    s_mov_b32 s44, 1
    s_cmp_eq_u32 s37, 0
    s_cbranch_scc1 t_nst0
    v_min_u32 v172, -2, v172
    v_min_u32 v173, -2, v173
    v_min_u32 v174, -2, v174
    v_min_u32 v175, -2, v175
    s_branch t_st0
t_bad1:
    s_mov_b32 s44, 1
    s_cmp_eq_u32 s37, 0
    s_cbranch_scc1 t_nst1
    v_min_u32 v176, -2, v176
    v_min_u32 v177, -2, v177
    v_min_u32 v178, -2, v178
    v_min_u32 v179, -2, v179
    s_branch t_st1
t_bad2:
    s_mov_b32 s44, 1
    s_cmp_eq_u32 s37, 0
    s_cbranch_scc1 t_vote
    v_min_u32 v180, -2, v180
    v_min_u32 v181, -2, v181
    v_min_u32 v182, -2, v182
    v_min_u32 v183, -2, v183
    s_branch t_st2
t_vote:
    ds_write_b32 v207, v206 offset:32
    s_branch t_nst2
t_svc:
    v_mfma_f32_16x16x32_bf16 v[232:235], v[0:3], v[128:131], v[232:235]
    v_mfma_f32_16x16x32_bf16 v[232:235], v[20:23], v[132:135], v[232:235]
    v_mfma_f32_16x16x32_bf16 v[236:239], v[4:7], v[128:131], v[236:239]
    v_mfma_f32_16x16x32_bf16 v[236:239], v[24:27], v[132:135], v[236:239]
    v_mfma_f32_16x16x32_bf16 v[240:243], v[8:11], v[128:131], v[240:243]
    v_mfma_f32_16x16x32_bf16 v[240:243], v[28:31], v[132:135], v[240:243]
    v_mfma_f32_16x16x32_bf16 v[244:247], v[12:15], v[128:131], v[244:247]
    v_mfma_f32_16x16x32_bf16 v[244:247], v[32:35], v[132:135], v[244:247]
    v_mfma_f32_16x16x32_bf16 v[248:251], v[16:19], v[128:131], v[248:251]
    v_mfma_f32_16x16x32_bf16 v[248:251], v[36:39], v[132:135], v[248:251]
    s_mul_i32 s40, s7, 5120
    s_add_u32 s40, s40, 116224
    v_add_u32 v204, s40, v200
    s_setprio 0
    ds_write_b128 v204, v[232:235] offset:0
    ds_write_b128 v204, v[236:239] offset:1024
    ds_write_b128 v204, v[240:243] offset:2048
    ds_write_b128 v204, v[244:247] offset:3072
    s_nop 0
    ds_write_b128 v204, v[248:251] offset:4096
    s_waitcnt lgkmcnt(0)
    s_barrier
    s_branch t_fin
a_f1_w:
    s_mov_b32 s46, 0
    ds_read_b32 v212, v255 offset:16
a_f1_sp:
    s_waitcnt lgkmcnt(0)
    v_cmp_ne_u32 vcc, -1, v212
    s_nop 0
    s_cmp_eq_u64 vcc, 0
    s_cbranch_scc1 a_f1_ok
    s_add_u32 s46, s46, 1
    s_cmp_gt_u32 s46, 2000000
    s_cbranch_scc1 a_f1_ok
    s_sleep 4
    ds_read_b32 v212, v255 offset:16
    s_branch a_f1_sp
a_f1_ok:
    s_branch a_f1_r
a_fk_w:
    s_mov_b32 s46, 0
    ds_read_b32 v212, v255 offset:80
a_fk_sp:
    s_waitcnt lgkmcnt(0)
    v_cmp_ne_u32 vcc, -1, v212
    s_nop 0
    s_cmp_eq_u64 vcc, 0
    s_cbranch_scc1 a_fk_ok
    s_add_u32 s46, s46, 1
    s_cmp_gt_u32 s46, 2000000
    s_cbranch_scc1 a_fk_ok
    s_sleep 4
    ds_read_b32 v212, v255 offset:80
    s_branch a_fk_sp
a_fk_ok:
    s_branch a_fk_r
t_dw:
    s_mov_b32 s46, 0
    buffer_load_dword v212, v227, s[20:23], s74 offen sc1
t_d_sp:
    s_waitcnt vmcnt(0)
    v_cmp_eq_u32 vcc, 0, v212
    s_nop 0
    s_cmp_eq_u64 vcc, 0
    s_cbranch_scc1 t_d_ok
    s_add_u32 s46, s46, 1
    s_cmp_gt_u32 s46, 2000000
    s_cbranch_scc1 t_d_ok
    buffer_load_dword v212, v227, s[20:23], s74 offen sc1
    s_branch t_d_sp
t_d_ok:
    s_branch t_dok
t_dfar:
    s_mov_b64 exec, 1
    buffer_store_dword v255, v226, s[20:23], s74 offen sc1
    s_branch t_dret
c_setup:
    v_lshrrev_b32 v206, 2, v231
    v_mul_u32_u24 v202, 160, v206
    v_and_b32 v206, 3, v231
    v_lshl_add_u32 v202, v206, 3, v202
    v_add_u32 v202, 102400, v202
    s_mov_b32 s20, s90
    s_and_b32 s21, s91, 0xffff
    s_mov_b32 s22, 524288
    s_mov_b32 s23, 0x20000
    s_mov_b32 s12, s72
    s_and_b32 s13, s73, 0xffff
    s_mov_b32 s14, 819200
    s_mov_b32 s15, 0x20000
    s_mov_b32 s68, s86
    s_and_b32 s69, s87, 0xffff
    s_mov_b32 s70, 2621440
    s_mov_b32 s71, 0x20000
    v_mul_u32_u24 v205, 6554, v231
    v_lshrrev_b32 v205, 16, v205
    v_mul_u32_u24 v201, 1120, v205
    s_mul_i32 s40, s6, 160
    v_add3_u32 v201, v201, v200, s40
    s_lshl_b32 s41, s5, 6
    s_lshl_b32 s42, s7, 4
    s_add_u32 s41, s41, s42
    s_lshl2_add_u32 s42, s41, 212992
    v_and_b32 v205, 15, v231
    v_lshl_add_u32 v229, v205, 2, s42
    s_mul_i32 s41, s41, 1280
    s_add_u32 s75, s40, s41
    s_xor_b32 s62, s3, 1
    s_mul_i32 s48, s5, 81920
    s_mul_i32 s40, s7, 20480
    s_add_u32 s48, s48, s40
    s_lshl_b32 s40, s6, 9
    s_add_u32 s48, s48, s40
    s_add_u32 s1, s48, 16384
    s_add_u32 s48, s48, s40
    s_add_u32 s0, s48, 8192
    s_lshl2_add_u32 s74, s5, s7
    s_lshl_b32 s74, s74, 6
    s_add_u32 s74, s74, 335872
    s_lshl1_add_u32 s40, s6, s3
    s_lshl_b32 s40, s40, 2
    v_mov_b32 v226, s40
    v_and_b32 v227, 15, v231
    v_lshlrev_b32 v227, 2, v227
    v_mov_b32 v170, 0
    s_mov_b32 s37, 0
    s_setpc_b64 s[92:93]
f_w567:
    s_setprio 3
    s_and_b32 s43, s4, 1
    s_lshl_b32 s58, s43, 10
    s_lshl_b32 s40, s43, 6
    v_xor_b32 v203, s40, v232
    v_add_u32 v204, s40, v231
    s_mul_i32 s41, s6, 160
    v_mul_u32_u24 v205, 6554, v204
    v_lshrrev_b32 v205, 16, v205
    v_and_b32 v206, 35, v205
    v_bfe_u32 v207, v205, 2, 2
    v_lshl_add_u32 v206, v207, 3, v206
    v_bfe_u32 v207, v205, 4, 1
    v_lshl_add_u32 v206, v207, 2, v206
    v_lshlrev_b32 v206, 3, v206
    v_sub_u32 v206, v206, v205
    v_mul_u32_u24 v206, 160, v206
    v_lshl_add_u32 v206, v204, 4, v206
    v_add_u32 v0, s41, v206
    v_add_u32 v204, 128, v204
    v_mul_u32_u24 v205, 6554, v204
    v_lshrrev_b32 v205, 16, v205
    v_and_b32 v206, 35, v205
    v_bfe_u32 v207, v205, 2, 2
    v_lshl_add_u32 v206, v207, 3, v206
    v_bfe_u32 v207, v205, 4, 1
    v_lshl_add_u32 v206, v207, 2, v206
    v_lshlrev_b32 v206, 3, v206
    v_sub_u32 v206, v206, v205
    v_mul_u32_u24 v206, 160, v206
    v_lshl_add_u32 v206, v204, 4, v206
    v_add_u32 v1, s41, v206
    v_add_u32 v204, 128, v204
    v_mul_u32_u24 v205, 6554, v204
    v_lshrrev_b32 v205, 16, v205
    v_and_b32 v206, 35, v205
    v_bfe_u32 v207, v205, 2, 2
    v_lshl_add_u32 v206, v207, 3, v206
    v_bfe_u32 v207, v205, 4, 1
    v_lshl_add_u32 v206, v207, 2, v206
    v_lshlrev_b32 v206, 3, v206
    v_sub_u32 v206, v206, v205
    v_mul_u32_u24 v206, 160, v206
    v_lshl_add_u32 v206, v204, 4, v206
    v_add_u32 v2, s41, v206
    v_add_u32 v204, 128, v204
    v_mul_u32_u24 v205, 6554, v204
    v_lshrrev_b32 v205, 16, v205
    v_and_b32 v206, 35, v205
    v_bfe_u32 v207, v205, 2, 2
    v_lshl_add_u32 v206, v207, 3, v206
    v_bfe_u32 v207, v205, 4, 1
    v_lshl_add_u32 v206, v207, 2, v206
    v_lshlrev_b32 v206, 3, v206
    v_sub_u32 v206, v206, v205
    v_mul_u32_u24 v206, 160, v206
    v_lshl_add_u32 v206, v204, 4, v206
    v_add_u32 v3, s41, v206
    v_add_u32 v204, 128, v204
    v_mul_u32_u24 v205, 6554, v204
    v_lshrrev_b32 v205, 16, v205
    v_and_b32 v206, 35, v205
    v_bfe_u32 v207, v205, 2, 2
    v_lshl_add_u32 v206, v207, 3, v206
    v_bfe_u32 v207, v205, 4, 1
    v_lshl_add_u32 v206, v207, 2, v206
    v_lshlrev_b32 v206, 3, v206
    v_sub_u32 v206, v206, v205
    v_mul_u32_u24 v206, 160, v206
    v_lshl_add_u32 v206, v204, 4, v206
    v_add_u32 v4, s41, v206
    v_add_u32 v204, 128, v204
    s_add_u32 s40, s33, 1
    s_and_b32 s40, s40, 3
    s_lshl_b32 s40, s40, 1
    s_add_u32 s40, s40, s43
    s_lshl_b32 s55, s40, 10
    s_mul_i32 s40, s40, 10240
    s_add_u32 s52, s40, s42
    s_add_u32 s40, s33, 2
    s_and_b32 s40, s40, 3
    s_lshl_b32 s40, s40, 1
    s_add_u32 s40, s40, s43
    s_lshl_b32 s56, s40, 10
    s_mul_i32 s40, s40, 10240
    s_add_u32 s53, s40, s42
    s_add_u32 s40, s33, 3
    s_and_b32 s40, s40, 3
    s_lshl_b32 s40, s40, 1
    s_add_u32 s40, s40, s43
    s_lshl_b32 s57, s40, 10
    s_mul_i32 s40, s40, 10240
    s_add_u32 s54, s40, s42
    s_waitcnt lgkmcnt(0)
    s_mov_b32 s8, s64
    s_and_b32 s9, s65, 0xffff
    s_mov_b32 s10, 2621440
    s_mov_b32 s11, 0x20000
    s_mov_b32 s28, s66
    s_and_b32 s29, s67, 0xffff
    s_mov_b32 s30, 819200
    s_mov_b32 s31, 0x20000
    s_setprio 2
    s_mov_b32 s46, 8000000
l_0_sp:
    ds_read_b32 v215, v240 offset:0
    s_waitcnt lgkmcnt(0)
    v_cmp_gt_u32 vcc, 5, v215
    s_sub_u32 s46, s46, 1
    s_cselect_b32 s40, 0, 1
    s_and_b32 s40, vcc_lo, s40
    s_cbranch_scc1 l_0_sp
l_0_ok:
    s_lshl_b32 s59, 4, s43
    v_mov_b32 v210, 1
    s_add_u32 s45, s32, 0
    s_cmp_ge_u32 s45, 5
    s_cselect_b32 s47, 5, 0
    s_sub_u32 s45, s45, s47
    s_mul_i32 s45, s45, 163840
    s_add_u32 m0, s58, 122880
    s_nop 0
    buffer_load_dwordx4 v0, s[28:31], s45 offen  lds
    s_add_u32 m0, s58, 124928
    s_nop 0
    buffer_load_dwordx4 v1, s[28:31], s45 offen  lds
    s_add_u32 m0, s58, 126976
    s_nop 0
    buffer_load_dwordx4 v2, s[28:31], s45 offen  lds
    s_add_u32 m0, s58, 129024
    s_nop 0
    buffer_load_dwordx4 v3, s[28:31], s45 offen  lds
    s_add_u32 m0, s58, 131072
    s_nop 0
    buffer_load_dwordx4 v4, s[28:31], s45 offen  lds
    s_add_u32 m0, s58, 133120
    s_add_u32 s45, s45, 81920
    buffer_load_dwordx4 v0, s[28:31], s45 offen  lds
    s_add_u32 m0, s58, 135168
    s_nop 0
    buffer_load_dwordx4 v1, s[28:31], s45 offen  lds
    s_add_u32 m0, s58, 137216
    s_nop 0
    buffer_load_dwordx4 v2, s[28:31], s45 offen  lds
    s_add_u32 m0, s58, 139264
    s_nop 0
    buffer_load_dwordx4 v3, s[28:31], s45 offen  lds
    s_add_u32 m0, s58, 141312
    s_nop 0
    buffer_load_dwordx4 v4, s[28:31], s45 offen  lds
    s_add_u32 s42, s32, 0
    s_cmp_ge_u32 s42, 5
    s_cselect_b32 s47, 5, 0
    s_sub_u32 s42, s42, s47
    s_lshl_b32 s42, s42, 8
    s_add_u32 s44, s42, 128
    s_add_u32 m0, s55, 0
    s_add_u32 s41, s42, s52
    buffer_load_dwordx4 v203, s[8:11], s41 offen  lds
    s_add_u32 m0, s55, 8192
    s_add_u32 s41, s44, s52
    buffer_load_dwordx4 v203, s[8:11], s41 offen  lds
    s_add_u32 m0, s56, 0
    s_add_u32 s41, s42, s53
    buffer_load_dwordx4 v203, s[8:11], s41 offen  lds
    s_add_u32 m0, s56, 8192
    s_add_u32 s41, s44, s53
    buffer_load_dwordx4 v203, s[8:11], s41 offen  lds
    s_add_u32 m0, s57, 0
    s_add_u32 s41, s42, s54
    buffer_load_dwordx4 v203, s[8:11], s41 offen  lds
    s_add_u32 m0, s57, 8192
    s_add_u32 s41, s44, s54
    buffer_load_dwordx4 v203, s[8:11], s41 offen  lds
    s_mov_b32 s49, s42
    s_call_b64 s[92:93], c_setup
    s_call_b64 s[92:93], s_setup
    s_mov_b32 s42, s49
    s_add_u32 s42, s32, 1
    s_cmp_ge_u32 s42, 5
    s_cselect_b32 s47, 5, 0
    s_sub_u32 s42, s42, s47
    s_lshl_b32 s42, s42, 8
    s_add_u32 s44, s42, 128
    s_add_u32 m0, s55, 16384
    s_add_u32 s41, s42, s52
    buffer_load_dwordx4 v203, s[8:11], s41 offen  lds
    s_add_u32 m0, s55, 24576
    s_add_u32 s41, s44, s52
    buffer_load_dwordx4 v203, s[8:11], s41 offen  lds
    s_add_u32 m0, s56, 16384
    s_add_u32 s41, s42, s53
    buffer_load_dwordx4 v203, s[8:11], s41 offen  lds
    s_add_u32 m0, s56, 24576
    s_add_u32 s41, s44, s53
    buffer_load_dwordx4 v203, s[8:11], s41 offen  lds
    s_add_u32 m0, s57, 16384
    s_add_u32 s41, s42, s54
    buffer_load_dwordx4 v203, s[8:11], s41 offen  lds
    s_add_u32 m0, s57, 24576
    s_add_u32 s41, s44, s54
    buffer_load_dwordx4 v203, s[8:11], s41 offen  lds
    s_add_u32 s45, s32, 1
    s_cmp_ge_u32 s45, 5
    s_cselect_b32 s47, 5, 0
    s_sub_u32 s45, s45, s47
    s_mul_i32 s45, s45, 163840
    s_add_u32 m0, s58, 143360
    s_nop 0
    buffer_load_dwordx4 v0, s[28:31], s45 offen  lds
    s_add_u32 m0, s58, 145408
    s_nop 0
    buffer_load_dwordx4 v1, s[28:31], s45 offen  lds
    s_add_u32 m0, s58, 147456
    s_nop 0
    buffer_load_dwordx4 v2, s[28:31], s45 offen  lds
    s_add_u32 m0, s58, 149504
    s_nop 0
    buffer_load_dwordx4 v3, s[28:31], s45 offen  lds
    s_add_u32 m0, s58, 151552
    s_nop 0
    buffer_load_dwordx4 v4, s[28:31], s45 offen  lds
    s_add_u32 m0, s58, 153600
    s_add_u32 s45, s45, 81920
    buffer_load_dwordx4 v0, s[28:31], s45 offen  lds
    s_add_u32 m0, s58, 155648
    s_nop 0
    buffer_load_dwordx4 v1, s[28:31], s45 offen  lds
    s_add_u32 m0, s58, 157696
    s_nop 0
    buffer_load_dwordx4 v2, s[28:31], s45 offen  lds
    s_add_u32 m0, s58, 159744
    s_nop 0
    buffer_load_dwordx4 v3, s[28:31], s45 offen  lds
    s_add_u32 m0, s58, 161792
    s_nop 0
    buffer_load_dwordx4 v4, s[28:31], s45 offen  lds
    s_mov_b32 s46, 8000000
l_a_sp:
    ds_read_b32 v215, v240 offset:0
    s_waitcnt lgkmcnt(0)
    v_cmp_gt_u32 vcc, 10, v215
    s_sub_u32 s46, s46, 1
    s_cselect_b32 s40, 0, 1
    s_and_b32 s40, vcc_lo, s40
    s_cbranch_scc1 l_a_sp
l_a_ok:
    s_waitcnt vmcnt(16)
    s_mov_b32 exec_lo, s59
    s_mov_b32 exec_hi, 0
    ds_add_u32 v240, v210
    s_mov_b64 exec, -1
    s_add_u32 s42, s32, 2
    s_cmp_ge_u32 s42, 5
    s_cselect_b32 s47, 5, 0
    s_sub_u32 s42, s42, s47
    s_lshl_b32 s42, s42, 8
    s_add_u32 s44, s42, 128
    s_add_u32 m0, s55, 32768
    s_add_u32 s41, s42, s52
    buffer_load_dwordx4 v203, s[8:11], s41 offen  lds
    s_add_u32 m0, s55, 40960
    s_add_u32 s41, s44, s52
    buffer_load_dwordx4 v203, s[8:11], s41 offen  lds
    s_add_u32 m0, s56, 32768
    s_add_u32 s41, s42, s53
    buffer_load_dwordx4 v203, s[8:11], s41 offen  lds
    s_add_u32 m0, s56, 40960
    s_add_u32 s41, s44, s53
    buffer_load_dwordx4 v203, s[8:11], s41 offen  lds
    s_add_u32 m0, s57, 32768
    s_add_u32 s41, s42, s54
    buffer_load_dwordx4 v203, s[8:11], s41 offen  lds
    s_add_u32 m0, s57, 40960
    s_add_u32 s41, s44, s54
    buffer_load_dwordx4 v203, s[8:11], s41 offen  lds
    s_add_u32 s45, s32, 2
    s_cmp_ge_u32 s45, 5
    s_cselect_b32 s47, 5, 0
    s_sub_u32 s45, s45, s47
    s_mul_i32 s45, s45, 163840
    s_add_u32 m0, s58, 81920
    s_nop 0
    buffer_load_dwordx4 v0, s[28:31], s45 offen  lds
    s_add_u32 m0, s58, 83968
    s_nop 0
    buffer_load_dwordx4 v1, s[28:31], s45 offen  lds
    s_add_u32 m0, s58, 86016
    s_nop 0
    buffer_load_dwordx4 v2, s[28:31], s45 offen  lds
    s_add_u32 m0, s58, 88064
    s_nop 0
    buffer_load_dwordx4 v3, s[28:31], s45 offen  lds
    s_add_u32 m0, s58, 90112
    s_nop 0
    buffer_load_dwordx4 v4, s[28:31], s45 offen  lds
    s_add_u32 m0, s58, 92160
    s_add_u32 s45, s45, 81920
    buffer_load_dwordx4 v0, s[28:31], s45 offen  lds
    s_add_u32 m0, s58, 94208
    s_nop 0
    buffer_load_dwordx4 v1, s[28:31], s45 offen  lds
    s_add_u32 m0, s58, 96256
    s_nop 0
    buffer_load_dwordx4 v2, s[28:31], s45 offen  lds
    s_add_u32 m0, s58, 98304
    s_nop 0
    buffer_load_dwordx4 v3, s[28:31], s45 offen  lds
    s_add_u32 m0, s58, 100352
    s_nop 0
    buffer_load_dwordx4 v4, s[28:31], s45 offen  lds
    s_waitcnt vmcnt(16)
    s_mov_b32 exec_lo, s59
    s_mov_b32 exec_hi, 0
    ds_add_u32 v240, v210
    s_mov_b64 exec, -1
    s_add_u32 s42, s32, 3
    s_cmp_ge_u32 s42, 5
    s_cselect_b32 s47, 5, 0
    s_sub_u32 s42, s42, s47
    s_lshl_b32 s42, s42, 8
    s_add_u32 s44, s42, 128
    s_add_u32 m0, s55, 49152
    s_add_u32 s41, s42, s52
    buffer_load_dwordx4 v203, s[8:11], s41 offen  lds
    s_add_u32 m0, s55, 57344
    s_add_u32 s41, s44, s52
    buffer_load_dwordx4 v203, s[8:11], s41 offen  lds
    s_add_u32 m0, s56, 49152
    s_add_u32 s41, s42, s53
    buffer_load_dwordx4 v203, s[8:11], s41 offen  lds
    s_add_u32 m0, s56, 57344
    s_add_u32 s41, s44, s53
    buffer_load_dwordx4 v203, s[8:11], s41 offen  lds
    s_add_u32 m0, s57, 49152
    s_add_u32 s41, s42, s54
    buffer_load_dwordx4 v203, s[8:11], s41 offen  lds
    s_add_u32 m0, s57, 57344
    s_add_u32 s41, s44, s54
    buffer_load_dwordx4 v203, s[8:11], s41 offen  lds
    s_mov_b32 s46, 8000000
l_b_sp:
    s_sleep 1
    ds_read_b32 v215, v240 offset:16
    s_waitcnt lgkmcnt(0)
    v_cmp_gt_u32 vcc, 1, v215
    s_sub_u32 s46, s46, 1
    s_cselect_b32 s40, 0, 15
    s_and_b32 s40, vcc_lo, s40
    s_cbranch_scc1 l_b_sp
l_b_ok:
    s_add_u32 s45, s32, 3
    s_cmp_ge_u32 s45, 5
    s_cselect_b32 s47, 5, 0
    s_sub_u32 s45, s45, s47
    s_mul_i32 s45, s45, 163840
    s_add_u32 m0, s58, 122880
    s_nop 0
    buffer_load_dwordx4 v0, s[28:31], s45 offen  lds
    s_add_u32 m0, s58, 124928
    s_nop 0
    buffer_load_dwordx4 v1, s[28:31], s45 offen  lds
    s_add_u32 m0, s58, 126976
    s_nop 0
    buffer_load_dwordx4 v2, s[28:31], s45 offen  lds
    s_add_u32 m0, s58, 129024
    s_nop 0
    buffer_load_dwordx4 v3, s[28:31], s45 offen  lds
    s_add_u32 m0, s58, 131072
    s_nop 0
    buffer_load_dwordx4 v4, s[28:31], s45 offen  lds
    s_add_u32 m0, s58, 133120
    s_add_u32 s45, s45, 81920
    buffer_load_dwordx4 v0, s[28:31], s45 offen  lds
    s_add_u32 m0, s58, 135168
    s_nop 0
    buffer_load_dwordx4 v1, s[28:31], s45 offen  lds
    s_add_u32 m0, s58, 137216
    s_nop 0
    buffer_load_dwordx4 v2, s[28:31], s45 offen  lds
    s_add_u32 m0, s58, 139264
    s_nop 0
    buffer_load_dwordx4 v3, s[28:31], s45 offen  lds
    s_add_u32 m0, s58, 141312
    s_nop 0
    buffer_load_dwordx4 v4, s[28:31], s45 offen  lds
    s_waitcnt vmcnt(16)
    s_mov_b32 exec_lo, s59
    s_mov_b32 exec_hi, 0
    ds_add_u32 v240, v210
    s_mov_b64 exec, -1
    s_add_u32 s42, s32, 4
    s_cmp_ge_u32 s42, 5
    s_cselect_b32 s47, 5, 0
    s_sub_u32 s42, s42, s47
    s_lshl_b32 s42, s42, 8
    s_add_u32 s44, s42, 128
    s_add_u32 m0, s55, 65536
    s_add_u32 s41, s42, s52
    buffer_load_dwordx4 v203, s[8:11], s41 offen  lds
    s_add_u32 m0, s55, 73728
    s_add_u32 s41, s44, s52
    buffer_load_dwordx4 v203, s[8:11], s41 offen  lds
    s_add_u32 m0, s56, 65536
    s_add_u32 s41, s42, s53
    buffer_load_dwordx4 v203, s[8:11], s41 offen  lds
    s_add_u32 m0, s56, 73728
    s_add_u32 s41, s44, s53
    buffer_load_dwordx4 v203, s[8:11], s41 offen  lds
    s_add_u32 m0, s57, 65536
    s_add_u32 s41, s42, s54
    buffer_load_dwordx4 v203, s[8:11], s41 offen  lds
    s_add_u32 m0, s57, 73728
    s_add_u32 s41, s44, s54
    buffer_load_dwordx4 v203, s[8:11], s41 offen  lds
    s_mov_b32 s46, 8000000
l_c_sp:
    s_sleep 1
    ds_read_b32 v215, v240 offset:16
    s_waitcnt lgkmcnt(0)
    v_cmp_gt_u32 vcc, 2, v215
    s_sub_u32 s46, s46, 1
    s_cselect_b32 s40, 0, 15
    s_and_b32 s40, vcc_lo, s40
    s_cbranch_scc1 l_c_sp
l_c_ok:
    s_add_u32 s45, s32, 4
    s_cmp_ge_u32 s45, 5
    s_cselect_b32 s47, 5, 0
    s_sub_u32 s45, s45, s47
    s_mul_i32 s45, s45, 163840
    s_add_u32 m0, s58, 143360
    s_nop 0
    buffer_load_dwordx4 v0, s[28:31], s45 offen  lds
    s_add_u32 m0, s58, 145408
    s_nop 0
    buffer_load_dwordx4 v1, s[28:31], s45 offen  lds
    s_add_u32 m0, s58, 147456
    s_nop 0
    buffer_load_dwordx4 v2, s[28:31], s45 offen  lds
    s_add_u32 m0, s58, 149504
    s_nop 0
    buffer_load_dwordx4 v3, s[28:31], s45 offen  lds
    s_add_u32 m0, s58, 151552
    s_nop 0
    buffer_load_dwordx4 v4, s[28:31], s45 offen  lds
    s_waitcnt vmcnt(16)
    s_mov_b32 exec_lo, s59
    s_mov_b32 exec_hi, 0
    ds_add_u32 v240, v210
    s_mov_b64 exec, -1
    s_add_u32 m0, s58, 153600
    s_add_u32 s45, s45, 81920
    buffer_load_dwordx4 v0, s[28:31], s45 offen  lds
    s_add_u32 m0, s58, 155648
    s_nop 0
    buffer_load_dwordx4 v1, s[28:31], s45 offen  lds
    s_add_u32 m0, s58, 157696
    s_nop 0
    buffer_load_dwordx4 v2, s[28:31], s45 offen  lds
    s_add_u32 m0, s58, 159744
    s_nop 0
    buffer_load_dwordx4 v3, s[28:31], s45 offen  lds
    s_add_u32 m0, s58, 161792
    s_nop 0
    buffer_load_dwordx4 v4, s[28:31], s45 offen  lds
    s_waitcnt vmcnt(16)
    s_mov_b32 exec_lo, s59
    s_mov_b32 exec_hi, 0
    ds_add_u32 v240, v210
    s_mov_b64 exec, -1
    s_waitcnt vmcnt(5)
    s_mov_b32 exec_lo, s59
    s_mov_b32 exec_hi, 0
    ds_add_u32 v240, v210
    s_mov_b64 exec, -1
    s_waitcnt vmcnt(0)
    s_mov_b32 exec_lo, s59
    s_mov_b32 exec_hi, 0
    ds_add_u32 v240, v210
    s_mov_b64 exec, -1
    s_branch s_start
f_w7b:
    s_waitcnt lgkmcnt(0)
    s_mov_b32 s8, s64
    s_and_b32 s9, s65, 0xffff
    s_mov_b32 s10, 2621440
    s_mov_b32 s11, 0x20000
    s_call_b64 s[92:93], c_setup
    s_setprio 3
    v_mov_b32 v0, 0
    v_add_u32 v204, 107520, v200
    s_lshr_b32 s43, s5, 1
    s_mul_i32 s43, s43, 10240
    s_lshl_b32 s44, s5, 1
    s_lshr_b32 s45, s33, 1
    s_add_u32 s44, s44, s45
    s_and_b32 s44, s44, 3
    s_and_b32 s45, s33, 1
    v_and_b32 v208, 15, v231
    v_bfe_u32 v209, v231, 4, 1
    v_lshrrev_b32 v210, 5, v231
    s_bitcmp1_b32 s6, 0
    s_cbranch_scc1 f_av
    v_add_u32 v205, 109312, v200
    v_mul_u32_u24 v206, 5120, v209
    v_lshl_add_u32 v206, v208, 4, v206
    v_lshl_add_u32 v206, v210, 3, v206
    s_lshl_b32 s40, s44, 9
    s_lshl_b32 s41, s45, 8
    s_add_u32 s40, s40, s41
    v_add_u32 v206, s40, v206
    s_and_b32 s40, s44, 1
    s_mul_i32 s40, s40, 5120
    s_add_u32 s40, s40, s41
    s_lshr_b32 s41, s44, 1
    s_lshl_b32 s41, s41, 3
    s_add_u32 s40, s40, s41
    s_add_u32 s40, s40, 4608
    v_add_u32 v207, s40, v200
    s_mov_b32 s42, 0x3ea52b5c
    s_branch f_ae
f_av:
    v_lshrrev_b32 v207, 2, v208
    v_lshlrev_b32 v205, 8, v207
    v_and_b32 v8, 3, v231
    v_lshl_add_u32 v205, v8, 4, v205
    v_add_u32 v205, 108736, v205
    v_mul_u32_u24 v206, 5120, v210
    v_lshl_add_u32 v206, v208, 4, v206
    v_lshl_add_u32 v206, v209, 3, v206
    s_lshl_b32 s40, s44, 1
    s_add_u32 s40, s40, s45
    s_mul_i32 s40, s40, 320
    s_add_u32 s40, s40, 2048
    v_add_u32 v206, s40, v206
    v_lshrrev_b32 v9, 1, v207
    v_mul_u32_u24 v9, 5120, v9
    v_lshl_add_u32 v9, v8, 4, v9
    v_and_b32 v207, 1, v207
    v_lshl_add_u32 v207, v207, 3, v9
    s_add_u32 s40, s40, 256
    v_add_u32 v207, s40, v207
    s_mov_b32 s42, 1.0
f_ae:
    s_mov_b32 s46, 8000000
f_c_sp:
    ds_read_b32 v215, v240 offset:0
    s_waitcnt lgkmcnt(0)
    v_cmp_gt_u32 vcc, 10, v215
    s_sub_u32 s46, s46, 1
    s_cselect_b32 s40, 0, 1
    s_and_b32 s40, vcc_lo, s40
    s_cbranch_scc1 f_c_sp
f_c_ok:
    ds_read_b128 v[8:11], v204 offset:0
    ds_read_b128 v[12:15], v205 offset:0
    ds_read_b128 v[16:19], v204 offset:3072
    ds_read_b128 v[20:23], v205 offset:3072
    ds_read_b128 v[24:27], v204 offset:6144
    ds_read_b128 v[28:31], v205 offset:6144
    ds_read_b128 v[32:35], v204 offset:9216
    ds_read_b128 v[36:39], v205 offset:9216
    ds_read_b128 v[40:43], v204 offset:12288
    ds_read_b128 v[44:47], v205 offset:12288
    s_waitcnt lgkmcnt(6)
    v_pk_add_f32 v[8:9], v[8:9], v[16:17]
    v_pk_add_f32 v[10:11], v[10:11], v[18:19]
    v_pk_add_f32 v[12:13], v[12:13], v[20:21]
    v_pk_add_f32 v[14:15], v[14:15], v[22:23]
    s_waitcnt lgkmcnt(4)
    v_pk_add_f32 v[8:9], v[8:9], v[24:25]
    v_pk_add_f32 v[10:11], v[10:11], v[26:27]
    v_pk_add_f32 v[12:13], v[12:13], v[28:29]
    v_pk_add_f32 v[14:15], v[14:15], v[30:31]
    s_waitcnt lgkmcnt(2)
    v_pk_add_f32 v[8:9], v[8:9], v[32:33]
    v_pk_add_f32 v[10:11], v[10:11], v[34:35]
    v_pk_add_f32 v[12:13], v[12:13], v[36:37]
    v_pk_add_f32 v[14:15], v[14:15], v[38:39]
    s_waitcnt lgkmcnt(0)
    v_pk_add_f32 v[8:9], v[8:9], v[40:41]
    v_pk_add_f32 v[10:11], v[10:11], v[42:43]
    v_pk_add_f32 v[12:13], v[12:13], v[44:45]
    v_pk_add_f32 v[14:15], v[14:15], v[46:47]
    v_mul_f32 v24, s42, v8
    v_mul_f32 v25, s42, v9
    v_mul_f32 v26, s42, v10
    v_mul_f32 v27, s42, v11
    v_mul_f32 v28, s42, v12
    v_mul_f32 v29, s42, v13
    v_mul_f32 v30, s42, v14
    v_mul_f32 v31, s42, v15
    v_cvt_pk_bf16_f32 v16, v24, v25
    v_cvt_pk_bf16_f32 v17, v26, v27
    v_cvt_pk_bf16_f32 v18, v28, v29
    v_cvt_pk_bf16_f32 v19, v30, v31
    buffer_store_dwordx2 v[16:17], v206, s[20:23], s43 offen sc1
    s_mov_b64 exec, 0xffff
    buffer_store_dwordx2 v[18:19], v207, s[20:23], s43 offen sc1
    s_mov_b64 exec, -1
    s_mov_b32 s34, 0
    s_bitcmp1_b32 s6, 0
    s_cbranch_scc1 f_nk
    v_mul_f32 v13, 0xbfb8aa3b, v13
    v_exp_f32 v13, v13
    s_lshl_b32 s40, s5, 6
    s_lshl_b32 s41, s33, 4
    s_add_u32 s40, s40, s41
    v_add_f32 v13, 1.0, v13
    v_rcp_f32 v13, v13
    v_add_u32 v20, s40, v208
    v_lshlrev_b32 v21, 2, v20
    s_mov_b32 s40, 212992
    s_mov_b32 exec_lo, 0xffff0000
    s_mov_b32 exec_hi, 0
    buffer_store_dword v13, v21, s[20:23], s40 offen sc1
    s_mov_b64 exec, -1
    v_sub_u32 v20, 2047, v20
    v_ashrrev_i32 v22, 31, v12
    v_or_b32 v22, 0x80000000, v22
    v_xor_b32 v22, v22, v12
    v_and_b32 v22, 0xffff8000, v22
    v_lshl_or_b32 v22, v20, 4, v22
    s_nop 1
    v_max_u32_dpp v22, v22, v22 row_shr:1
    s_nop 1
    v_max_u32_dpp v22, v22, v22 row_shr:2
    s_nop 1
    v_max_u32_dpp v22, v22, v22 row_shr:4
    s_nop 1
    v_max_u32_dpp v22, v22, v22 row_shr:8
    s_nop 1
    v_readlane_b32 s34, v22, 31
    s_nop 1
f_nk:
    v_mov_b32 v210, 1
    s_mov_b64 exec, 1
    ds_add_u32 v240, v210
    s_mov_b64 exec, -1
    s_getreg_b32 s40, hwreg(HW_REG_XCC_ID, 0, 3)
    s_or_b32 s40, s40, 8
    s_or_b32 s34, s34, s40
    s_and_b32 s40, s2, 63
    s_lshl_b32 s40, s40, 7
    s_lshr_b32 s41, s2, 6
    s_lshl_b32 s41, s41, 2
    s_add_u32 s40, s40, s41
    s_add_u32 s43, s40, 196608
    v_mov_b64 v[48:49], 0
    v_mov_b64 v[50:51], 0
    v_add_u32 v204, 112640, v200
    v_mul_u32_u24 v205, 320, v231
    v_add_u32 v205, 112960, v205
    v_mov_b32 v52, 0x3f803f80
    v_mov_b32 v53, 0x3f803f80
    v_mov_b64 v[54:55], v[52:53]
    ds_write_b128 v204, v[48:51]
    ds_write_b128 v204, v[48:51] offset:1024
    ds_write_b128 v204, v[48:51] offset:2048
    s_mov_b64 exec, 0xff
    ds_write_b128 v205, v[52:55]
    s_mov_b64 exec, -1
    s_mov_b32 s46, 8000000
g_p_sp:
    ds_read_b32 v215, v240 offset:0
    s_waitcnt lgkmcnt(0)
    v_cmp_gt_u32 vcc, 1, v215
    s_sub_u32 s46, s46, 1
    s_cselect_b32 s40, 0, 2
    s_and_b32 s40, vcc_lo, s40
    s_cbranch_scc1 g_p_sp
g_p_ok:
    s_waitcnt vmcnt(0)
    s_atomic_or s34, s[90:91], s43
    s_branch f_w47
f_w4:
    s_load_dword s63, s[88:89], 0
    s_mov_b32 s28, s88
    s_and_b32 s29, s89, 0xffff
    s_mov_b32 s30, 256
    s_mov_b32 s31, 0x20000
    v_mov_b32 v0, 0
    s_waitcnt lgkmcnt(0)
    s_mov_b32 s46, 0
g_g_sp:
    s_cmp_lg_u32 s63, 0
    s_cbranch_scc1 g_g_ok
    s_add_u32 s46, s46, 1
    s_cmp_gt_u32 s46, 2000000
    s_cbranch_scc1 g_g_ok
    s_sleep 2
    buffer_load_dword v212, v0, s[28:31], 0 offen sc1
    s_waitcnt vmcnt(0)
    v_readfirstlane_b32 s63, v212
    s_nop 0
    s_branch g_g_sp
g_g_ok:
    s_mov_b64 exec, 2
    ds_add_u32 v240, v210
    s_mov_b64 exec, -1
f_w47:
    s_setprio 1
    s_call_b64 s[92:93], s_setup
    v_and_b32 v210, 7, v231
    v_lshlrev_b32 v210, 10, v210
    s_and_b32 s40, s2, 7
    s_lshl_b32 s41, s40, 7
    v_add_u32 v210, s41, v210
    s_mov_b32 s43, 196608
    s_and_b32 s44, s4, 1
    s_mul_i32 s44, s44, 5120
    s_mul_i32 s45, s40, 20480
    s_add_u32 s45, s45, s44
    s_mov_b32 s46, 8000000
f_x_sp:
    s_sleep 2
    ds_read_b32 v215, v240 offset:16
    s_waitcnt lgkmcnt(0)
    v_cmp_gt_u32 vcc, 3, v215
    s_sub_u32 s46, s46, 1
    s_cselect_b32 s40, 0, 15
    s_and_b32 s40, vcc_lo, s40
    s_cbranch_scc1 f_x_sp
f_x_ok:
    s_setprio 3
    s_mov_b32 s46, 0
    buffer_load_dwordx4 v[212:215], v210, s[20:23], s43 offen sc1
f_ps_sp:
    s_waitcnt vmcnt(0)
    v_min3_u32 v209, v212, v213, v214
    v_min_u32 v209, v209, v215
    v_cmp_eq_u32 vcc, 0, v209
    s_nop 1
    s_cmp_eq_u64 vcc, 0
    s_cbranch_scc1 f_ps_ok
    s_add_u32 s46, s46, 1
    s_cmp_gt_u32 s46, 2000000
    s_cbranch_scc1 f_ps_ok
    s_sleep 4
    buffer_load_dwordx4 v[212:215], v210, s[20:23], s43 offen sc1
    s_branch f_ps_sp
f_ps_ok:
    s_add_u32 m0, s44, 0
    s_add_u32 s40, s45, 0
    buffer_load_dwordx4 v200, s[20:23], s40 offen sc1 lds
    buffer_load_dwordx4 v200, s[20:23], s40 offen offset:1024 sc1 lds
    buffer_load_dwordx4 v200, s[20:23], s40 offen offset:2048 sc1 lds
    buffer_load_dwordx4 v200, s[20:23], s40 offen offset:3072 sc1 lds
    s_add_u32 m0, s44, 4096
    s_add_u32 s40, s45, 4096
    buffer_load_dwordx4 v200, s[20:23], s40 offen sc1 lds
    s_add_u32 m0, s44, 10240
    s_add_u32 s40, s45, 10240
    buffer_load_dwordx4 v200, s[20:23], s40 offen sc1 lds
    buffer_load_dwordx4 v200, s[20:23], s40 offen offset:1024 sc1 lds
    buffer_load_dwordx4 v200, s[20:23], s40 offen offset:2048 sc1 lds
    buffer_load_dwordx4 v200, s[20:23], s40 offen offset:3072 sc1 lds
    s_add_u32 m0, s44, 14336
    s_add_u32 s40, s45, 14336
    buffer_load_dwordx4 v200, s[20:23], s40 offen sc1 lds
    s_waitcnt vmcnt(5)
    s_branch s_start
s_setup:
    v_mov_b64 v[128:129], -1
    v_mov_b64 v[130:131], -1
    v_lshlrev_b32 v132, 2, v231
    v_lshlrev_b32 v133, 3, v231
    v_lshlrev_b32 v134, 7, v231
    s_lshl2_add_u32 s40, s7, 112640
    v_mov_b32 v135, s40
    v_and_b32 v136, 28, v132
    v_min_u32 v137, 6784, v134
    v_and_b32 v204, 15, v231
    v_mul_u32_u24 v204, 2560, v204
    v_lshrrev_b32 v205, 4, v231
    v_mul_u32_u24 v143, 640, v205
    v_add_u32 v143, v143, v204
    s_mul_i32 s40, s7, 80
    s_add_u32 s40, s40, 112640
    v_lshl_add_u32 v139, v205, 2, s40
    v_mov_b64 v[72:73], 0
    v_mov_b64 v[74:75], 0
    v_mov_b64 v[76:77], 0
    v_and_b32 v204, 15, v231
    v_mul_u32_u24 v140, 1280, v204
    v_lshl_add_u32 v140, v205, 3, v140
    v_lshlrev_b32 v141, 4, v205
    v_add_u32 v141, 112640, v141
    s_bitcmp1_b32 s2, 7
    s_cselect_b32 s78, s80, s78
    s_cselect_b32 s79, s81, s79
    s_mov_b32 s24, s78
    s_and_b32 s25, s79, 0xffff
    s_mov_b32 s26, 2211840
    s_mov_b32 s27, 0x20000
    s_mov_b32 s16, s82
    s_and_b32 s17, s83, 0xffff
    s_mov_b32 s18, 2211840
    s_mov_b32 s19, 0x20000
    s_setpc_b64 s[92:93]
s_start:
    v_mov_b32 v210, v134
    s_mov_b32 s43, 196608
    s_setprio 3
    s_barrier
    buffer_load_dwordx4 v[212:215], v210, s[20:23], s43 offen sc1
    s_waitcnt vmcnt(1)
    ds_write_b32 v135, v128 offset:16
    s_mov_b32 s46, 0
s_g_sp:
    s_waitcnt vmcnt(0)
    v_min3_u32 v209, v212, v213, v214
    v_min_u32 v209, v209, v215
    v_cmp_eq_u32 vcc, 0, v209
    s_nop 1
    s_cmp_eq_u64 vcc, 0
    s_cbranch_scc1 s_g_ok
    s_add_u32 s46, s46, 1
    s_cmp_gt_u32 s46, 2000000
    s_cbranch_scc1 s_g_ok
    s_sleep 2
    buffer_load_dwordx4 v[212:215], v210, s[20:23], s43 offen sc1
    s_branch s_g_sp
s_g_ok:
    v_max3_u32 v209, v212, v213, v214
    v_max_u32 v209, v209, v215
    s_getreg_b32 s40, hwreg(HW_REG_XCC_ID, 0, 3)
    v_xor_b32 v213, v212, v213
    v_max_u32_dpp v209, v209, v209 row_shr:1
    v_bitop3_b32 v214, v212, v214, v215 bitop3:0x7e
    v_xor_b32 v212, s40, v212
    v_max_u32_dpp v209, v209, v209 row_shr:2
    v_or3_b32 v212, v212, v213, v214
    v_and_b32 v212, 7, v212
    v_max_u32_dpp v209, v209, v209 row_shr:4
    v_cmp_ne_u32 vcc, 0, v212
    s_and_b32 s40, s2, 7
    v_max_u32_dpp v209, v209, v209 row_shr:8
    s_lshl_b32 s40, 0x01010101, s40
    s_or_b32 s41, vcc_lo, vcc_hi
    v_max_u32_dpp v209, v209, v209 row_bcast:15 row_mask:0xa
    s_and_b32 s41, s41, s40
    s_cselect_b32 s63, 0, 1
    v_max_u32_dpp v209, v209, v209 row_bcast:31 row_mask:0xc
    s_nop 0
    v_readlane_b32 s34, v209, 63
    v_mov_b32 v153, s63
    s_bfe_u32 s40, s34, 0xb0004
    s_sub_u32 s40, 2047, s40
    s_lshl_b32 s41, s5, 6
    s_sub_u32 s35, s40, s41
    v_mov_b32 v152, s35
    s_mul_i32 s40, s62, 10240
    s_add_u32 s40, s40, 4294875136
    v_add_u32 v209, s40, v202
    v_add_u32 v210, 61440, v209
    s_setprio 1
    s_lshl_b32 s42, s2, 2
    s_add_u32 s42, s42, s7
    s_bfe_u32 s44, s2, 131073
    s_lshl2_add_u32 s44, s44, s7
    s_add_u32 s40, s35, s41
    s_mul_i32 s40, s40, 1280
    s_mul_i32 s41, s44, 80
    s_add_u32 s40, s40, s41
    s_add_u32 s50, s64, s40
    s_addc_u32 s51, s65, 0
    s_load_dwordx8 s[52:59], s[50:51], 0
    s_load_dwordx2 s[60:61], s[50:51], 32
    s_load_dwordx8 s[76:83], s[50:51], 40
    s_load_dwordx2 s[84:85], s[50:51], 72
    s_bfe_u32 s49, s42, 0x40005
    s_mul_i32 s49, s49, 216
    s_mul_i32 s36, s44, 138240
    s_add_u32 s36, s36, s49
    s_mul_i32 s46, s7, 5120
    s_add_u32 s42, s46, 20480
    s_add_u32 s43, s6, 0
s_r1:
    s_cmp_ge_u32 s43, 7
    s_cselect_b32 s45, 7, 0
    s_sub_u32 s43, s43, s45
    s_add_u32 s43, s43, 1
    s_add_u32 s45, s2, s43
    s_and_b32 s45, s45, 7
    s_mov_b32 m0, s42
    s_mul_i32 s40, s45, 20480
    s_add_u32 s40, s40, s46
    buffer_load_dwordx4 v200, s[20:23], s40 offen sc1 lds
    buffer_load_dwordx4 v200, s[20:23], s40 offen offset:1024 sc1 lds
    buffer_load_dwordx4 v200, s[20:23], s40 offen offset:2048 sc1 lds
    buffer_load_dwordx4 v200, s[20:23], s40 offen offset:3072 sc1 lds
    s_add_u32 m0, m0, 4096
    s_add_u32 s40, s40, 4096
    buffer_load_dwordx4 v200, s[20:23], s40 offen sc1 lds
    s_add_u32 s42, s42, 20480
    s_cmp_lt_u32 s42, 81920
    s_cbranch_scc1 s_r1
    s_mov_b32 s37, 2
    s_branch a_pad0
a_back0:
    s_branch a_pad1
a_back1:
    s_branch a_pad2
a_back2:
    s_branch a_pad3
a_back3:
    s_mov_b32 s37, 0
    s_waitcnt vmcnt(0) lgkmcnt(0)
s_s1:
    s_barrier
    s_mov_b64 exec, 1
    ds_write_b64 v255, v[152:153] offset:48
    s_mov_b64 exec, -1
    s_cmp_eq_u32 s37, 0
    s_cbranch_scc0 s_k
    s_bitcmp1_b32 s2, 0
    s_cbranch_scc1 s_n1
    buffer_load_dword v0, v132, s[24:27], s36 offen nt
    buffer_load_dword v1, v132, s[24:27], s36 offen offset:3456 nt
    s_add_u32 s36, s36, 6912
    buffer_load_dword v2, v132, s[24:27], s36 offen nt
    buffer_load_dword v3, v132, s[24:27], s36 offen offset:3456 nt
    s_add_u32 s36, s36, 6912
    buffer_load_dword v4, v132, s[24:27], s36 offen nt
    buffer_load_dword v5, v132, s[24:27], s36 offen offset:3456 nt
    s_add_u32 s36, s36, 6912
    buffer_load_dword v6, v132, s[24:27], s36 offen nt
    buffer_load_dword v7, v132, s[24:27], s36 offen offset:3456 nt
    s_add_u32 s36, s36, 6912
    buffer_load_dword v8, v132, s[24:27], s36 offen nt
    buffer_load_dword v9, v132, s[24:27], s36 offen offset:3456 nt
    s_add_u32 s36, s36, 6912
    buffer_load_dword v10, v132, s[24:27], s36 offen nt
    buffer_load_dword v11, v132, s[24:27], s36 offen offset:3456 nt
    s_add_u32 s36, s36, 6912
    buffer_load_dword v12, v132, s[24:27], s36 offen nt
    buffer_load_dword v13, v132, s[24:27], s36 offen offset:3456 nt
    s_add_u32 s36, s36, 6912
    buffer_load_dword v14, v132, s[24:27], s36 offen nt
    buffer_load_dword v15, v132, s[24:27], s36 offen offset:3456 nt
    s_add_u32 s36, s36, 6912
    buffer_load_dword v16, v132, s[24:27], s36 offen nt
    buffer_load_dword v17, v132, s[24:27], s36 offen offset:3456 nt
    s_add_u32 s36, s36, 6912
    buffer_load_dword v18, v132, s[24:27], s36 offen nt
    buffer_load_dword v19, v132, s[24:27], s36 offen offset:3456 nt
    s_add_u32 s36, s36, 6912
    buffer_load_dword v20, v132, s[24:27], s36 offen nt
    buffer_load_dword v21, v132, s[24:27], s36 offen offset:3456 nt
    s_add_u32 s36, s36, 6912
    buffer_load_dword v22, v132, s[24:27], s36 offen nt
    buffer_load_dword v23, v132, s[24:27], s36 offen offset:3456 nt
    s_add_u32 s36, s36, 6912
    buffer_load_dword v24, v132, s[24:27], s36 offen nt
    buffer_load_dword v25, v132, s[24:27], s36 offen offset:3456 nt
    s_add_u32 s36, s36, 6912
    buffer_load_dword v26, v132, s[24:27], s36 offen nt
    buffer_load_dword v27, v132, s[24:27], s36 offen offset:3456 nt
    s_add_u32 s36, s36, 6912
    buffer_load_dword v28, v132, s[24:27], s36 offen nt
    buffer_load_dword v29, v132, s[24:27], s36 offen offset:3456 nt
    s_add_u32 s36, s36, 6912
    buffer_load_dword v30, v132, s[24:27], s36 offen nt
    buffer_load_dword v31, v132, s[24:27], s36 offen offset:3456 nt
    s_add_u32 s36, s36, 6912
    buffer_load_dword v32, v132, s[24:27], s36 offen nt
    buffer_load_dword v33, v132, s[24:27], s36 offen offset:3456 nt
    s_add_u32 s36, s36, 6912
    buffer_load_dword v34, v132, s[24:27], s36 offen nt
    buffer_load_dword v35, v132, s[24:27], s36 offen offset:3456 nt
    s_add_u32 s36, s36, 6912
    buffer_load_dword v36, v132, s[24:27], s36 offen nt
    buffer_load_dword v37, v132, s[24:27], s36 offen offset:3456 nt
    s_add_u32 s36, s36, 6912
    buffer_load_dword v38, v132, s[24:27], s36 offen nt
    buffer_load_dword v39, v132, s[24:27], s36 offen offset:3456 nt
    s_add_u32 s36, s36, 6912
    s_mov_b32 s42, 0x05040100
    s_mov_b32 s43, 0x07060302
    s_waitcnt vmcnt(0)
    s_setprio 3
    v_perm_b32 v204, v1, v0, s42
    v_perm_b32 v205, v1, v0, s43
    v_dot2c_f32_bf16 v76, s52, v204
    v_dot2c_f32_bf16 v77, s52, v205
    v_perm_b32 v204, v3, v2, s42
    v_perm_b32 v205, v3, v2, s43
    v_dot2c_f32_bf16 v76, s53, v204
    v_dot2c_f32_bf16 v77, s53, v205
    v_perm_b32 v204, v5, v4, s42
    v_perm_b32 v205, v5, v4, s43
    v_dot2c_f32_bf16 v76, s54, v204
    v_dot2c_f32_bf16 v77, s54, v205
    v_perm_b32 v204, v7, v6, s42
    v_perm_b32 v205, v7, v6, s43
    v_dot2c_f32_bf16 v76, s55, v204
    v_dot2c_f32_bf16 v77, s55, v205
    v_perm_b32 v204, v9, v8, s42
    v_perm_b32 v205, v9, v8, s43
    v_dot2c_f32_bf16 v76, s56, v204
    v_dot2c_f32_bf16 v77, s56, v205
    v_perm_b32 v204, v11, v10, s42
    v_perm_b32 v205, v11, v10, s43
    v_dot2c_f32_bf16 v76, s57, v204
    v_dot2c_f32_bf16 v77, s57, v205
    v_perm_b32 v204, v13, v12, s42
    v_perm_b32 v205, v13, v12, s43
    v_dot2c_f32_bf16 v76, s58, v204
    v_dot2c_f32_bf16 v77, s58, v205
    v_perm_b32 v204, v15, v14, s42
    v_perm_b32 v205, v15, v14, s43
    v_dot2c_f32_bf16 v76, s59, v204
    v_dot2c_f32_bf16 v77, s59, v205
    v_perm_b32 v204, v17, v16, s42
    v_perm_b32 v205, v17, v16, s43
    v_dot2c_f32_bf16 v76, s60, v204
    v_dot2c_f32_bf16 v77, s60, v205
    v_perm_b32 v204, v19, v18, s42
    v_perm_b32 v205, v19, v18, s43
    v_dot2c_f32_bf16 v76, s61, v204
    v_dot2c_f32_bf16 v77, s61, v205
    v_perm_b32 v204, v21, v20, s42
    v_perm_b32 v205, v21, v20, s43
    v_dot2c_f32_bf16 v76, s76, v204
    v_dot2c_f32_bf16 v77, s76, v205
    v_perm_b32 v204, v23, v22, s42
    v_perm_b32 v205, v23, v22, s43
    v_dot2c_f32_bf16 v76, s77, v204
    v_dot2c_f32_bf16 v77, s77, v205
    v_perm_b32 v204, v25, v24, s42
    v_perm_b32 v205, v25, v24, s43
    v_dot2c_f32_bf16 v76, s78, v204
    v_dot2c_f32_bf16 v77, s78, v205
    v_perm_b32 v204, v27, v26, s42
    v_perm_b32 v205, v27, v26, s43
    v_dot2c_f32_bf16 v76, s79, v204
    v_dot2c_f32_bf16 v77, s79, v205
    v_perm_b32 v204, v29, v28, s42
    v_perm_b32 v205, v29, v28, s43
    v_dot2c_f32_bf16 v76, s80, v204
    v_dot2c_f32_bf16 v77, s80, v205
    v_perm_b32 v204, v31, v30, s42
    v_perm_b32 v205, v31, v30, s43
    v_dot2c_f32_bf16 v76, s81, v204
    v_dot2c_f32_bf16 v77, s81, v205
    v_perm_b32 v204, v33, v32, s42
    v_perm_b32 v205, v33, v32, s43
    v_dot2c_f32_bf16 v76, s82, v204
    v_dot2c_f32_bf16 v77, s82, v205
    v_perm_b32 v204, v35, v34, s42
    v_perm_b32 v205, v35, v34, s43
    v_dot2c_f32_bf16 v76, s83, v204
    v_dot2c_f32_bf16 v77, s83, v205
    v_perm_b32 v204, v37, v36, s42
    v_perm_b32 v205, v37, v36, s43
    v_dot2c_f32_bf16 v76, s84, v204
    v_dot2c_f32_bf16 v77, s84, v205
    v_perm_b32 v204, v39, v38, s42
    v_perm_b32 v205, v39, v38, s43
    v_dot2c_f32_bf16 v76, s85, v204
    v_dot2c_f32_bf16 v77, s85, v205
    s_setprio 1
    s_lshr_b32 s40, s2, 7
    s_mul_i32 s40, s40, 6912
    s_add_u32 s40, s40, s49
    s_add_u32 s40, s40, 262144
    s_mov_b32 exec_hi, 0x3fffff
    buffer_atomic_add_f32 v76, v132, s[20:23], s40 offen
    buffer_atomic_add_f32 v77, v132, s[20:23], s40 offen offset:3456
    s_mov_b32 exec_hi, -1
s_n1:
    buffer_store_dwordx4 v[128:131], v200, s[68:71], s48 offen sc1
    buffer_store_dwordx4 v[128:131], v200, s[68:71], s0 offen sc1
    s_mov_b32 exec_hi, 0
    buffer_store_dwordx4 v[128:131], v200, s[68:71], s1 offen sc1
    s_mov_b32 exec_hi, -1
s_k:
    s_mul_i32 s46, s7, 5120
    s_add_u32 s42, s46, 81920
    s_add_u32 s43, s6, 3
s_r2:
    s_cmp_ge_u32 s43, 7
    s_cselect_b32 s45, 7, 0
    s_sub_u32 s43, s43, s45
    s_add_u32 s43, s43, 1
    s_add_u32 s45, s2, s43
    s_and_b32 s45, s45, 7
    s_cmp_ge_u32 s42, 112640
    s_cselect_b32 s44, 10240, 0
    s_cmp_ge_u32 s42, 153600
    s_cselect_b32 s44, 4294813696, s44
    s_add_u32 m0, s42, s44
    s_mul_i32 s40, s45, 20480
    s_add_u32 s40, s40, s46
    buffer_load_dwordx4 v200, s[20:23], s40 offen sc1 lds
    buffer_load_dwordx4 v200, s[20:23], s40 offen offset:1024 sc1 lds
    buffer_load_dwordx4 v200, s[20:23], s40 offen offset:2048 sc1 lds
    buffer_load_dwordx4 v200, s[20:23], s40 offen offset:3072 sc1 lds
    s_add_u32 m0, m0, 4096
    s_add_u32 s40, s40, 4096
    buffer_load_dwordx4 v200, s[20:23], s40 offen sc1 lds
    s_add_u32 s42, s42, 20480
    s_cmp_lt_u32 s42, 163840
    s_cbranch_scc1 s_r2
    s_waitcnt vmcnt(0)
    ds_write_b32 v135, v128 offset:80
    s_cmp_eq_u32 s37, 0
    s_cbranch_scc0 s_k2
    s_lshr_b32 s40, s2, 2
    s_lshl_b32 s40, s40, 7
    s_add_u32 s40, s40, 319488
    s_mov_b32 s41, 1
    s_waitcnt vmcnt(0)
    s_atomic_add s41, s[90:91], s40
    s_waitcnt lgkmcnt(0)
    s_bitcmp1_b32 s2, 0
    s_cbranch_scc1 s_n2
    s_and_b32 s40, s2, -2
    s_mul_i32 s40, s40, 10240
    s_mul_i32 s41, s7, 320
    s_add_u32 s40, s40, s41
    buffer_load_dwordx2 v[40:41], v133, s[16:19], s40 offen offset:0 nt
    buffer_load_dwordx2 v[42:43], v133, s[16:19], s40 offen offset:1280 nt
    buffer_load_dwordx2 v[44:45], v133, s[16:19], s40 offen offset:2560 nt
    buffer_load_dwordx2 v[46:47], v133, s[16:19], s40 offen offset:3840 nt
    s_add_u32 s40, s40, 5120
    buffer_load_dwordx2 v[48:49], v133, s[16:19], s40 offen offset:0 nt
    buffer_load_dwordx2 v[50:51], v133, s[16:19], s40 offen offset:1280 nt
    buffer_load_dwordx2 v[52:53], v133, s[16:19], s40 offen offset:2560 nt
    buffer_load_dwordx2 v[54:55], v133, s[16:19], s40 offen offset:3840 nt
    s_add_u32 s40, s40, 5120
    buffer_load_dwordx2 v[56:57], v133, s[16:19], s40 offen offset:0 nt
    buffer_load_dwordx2 v[58:59], v133, s[16:19], s40 offen offset:1280 nt
    buffer_load_dwordx2 v[60:61], v133, s[16:19], s40 offen offset:2560 nt
    buffer_load_dwordx2 v[62:63], v133, s[16:19], s40 offen offset:3840 nt
    s_add_u32 s40, s40, 5120
    buffer_load_dwordx2 v[64:65], v133, s[16:19], s40 offen offset:0 nt
    buffer_load_dwordx2 v[66:67], v133, s[16:19], s40 offen offset:1280 nt
    buffer_load_dwordx2 v[68:69], v133, s[16:19], s40 offen offset:2560 nt
    buffer_load_dwordx2 v[70:71], v133, s[16:19], s40 offen offset:3840 nt
    s_add_u32 s40, s40, 5120
s_n2:
    s_lshr_b32 s40, s2, 3
    s_lshl_b32 s40, s40, 2
    s_add_u32 s40, s40, s7
    s_mul_i32 s40, s40, 6400
    s_mov_b32 exec_hi, 0x3ffff
    buffer_load_dword v208, v134, s[12:15], s40 offen
    s_mov_b32 exec_hi, -1
    buffer_load_dwordx2 v[216:217], v140, s[8:11], s75 offen offset:0
    buffer_load_dwordx2 v[218:219], v140, s[8:11], s75 offen offset:32
    buffer_load_dwordx2 v[220:221], v140, s[8:11], s75 offen offset:64
    buffer_load_dwordx2 v[222:223], v140, s[8:11], s75 offen offset:96
    buffer_load_dwordx2 v[224:225], v140, s[8:11], s75 offen offset:128
    buffer_load_dword v228, v229, s[20:23], 0 offen sc1
s_k2:
    s_mov_b32 s46, 0
    ds_read_b32 v212, v255 offset:64
s_fd1_sp:
    s_waitcnt lgkmcnt(0)
    v_cmp_ne_u32 vcc, -1, v212
    s_nop 0
    s_cmp_eq_u64 vcc, 0
    s_cbranch_scc1 s_fd1_ok
    s_add_u32 s46, s46, 1
    s_cmp_gt_u32 s46, 2000000
    s_cbranch_scc1 s_fd1_ok
    s_sleep 4
    ds_read_b32 v212, v255 offset:64
    s_branch s_fd1_sp
s_fd1_ok:
    s_lshr_b32 s40, s7, 1
    s_and_b32 s41, s7, 1
    s_mul_i32 s43, s40, 51200
    s_mul_i32 s44, s41, 5120
    s_add_u32 s45, s43, s44
    s_mul_i32 s42, s7, 640
    s_add_u32 s42, s42, 10240
    s_add_u32 s47, s32, 0
    s_mov_b32 exec_hi, 0xff
s_wa:
    s_and_b32 s46, s47, 3
    s_mul_i32 s46, s46, 204800
    s_add_u32 s46, s46, s45
    s_add_u32 s47, s47, 1
    s_add_u32 m0, s42, 0
    s_add_u32 s40, s46, 0
    buffer_load_dwordx4 v201, s[12:15], s40 offen  lds
    s_add_u32 m0, s42, 2560
    s_add_u32 s40, s46, 10240
    buffer_load_dwordx4 v201, s[12:15], s40 offen  lds
    s_add_u32 m0, s42, 5120
    s_add_u32 s40, s46, 102400
    buffer_load_dwordx4 v201, s[12:15], s40 offen  lds
    s_add_u32 m0, s42, 7680
    s_add_u32 s40, s46, 112640
    buffer_load_dwordx4 v201, s[12:15], s40 offen  lds
    s_add_u32 m0, s42, 10240
    s_add_u32 s40, s46, 25600
    buffer_load_dwordx4 v201, s[12:15], s40 offen  lds
    s_add_u32 m0, s42, 12800
    s_add_u32 s40, s46, 35840
    buffer_load_dwordx4 v201, s[12:15], s40 offen  lds
    s_add_u32 m0, s42, 15360
    s_add_u32 s40, s46, 128000
    buffer_load_dwordx4 v201, s[12:15], s40 offen  lds
    s_add_u32 m0, s42, 17920
    s_add_u32 s40, s46, 138240
    buffer_load_dwordx4 v201, s[12:15], s40 offen  lds
    s_add_u32 s42, s42, 20480
    s_cmp_lt_u32 s42, 71680
    s_cbranch_scc1 s_wa
    s_mov_b32 exec_hi, -1
    s_cmp_eq_u32 s37, 0
    s_cbranch_scc0 s_wo
    s_mov_b32 s44, 319488
    s_mov_b32 s46, 0
    buffer_load_dword v206, v134, s[20:23], s44 offen sc1
s_c1_sp:
    s_waitcnt vmcnt(0)
    v_cmp_ne_u32 vcc, 16, v206
    s_nop 1
    s_cmp_eq_u64 vcc, 0
    s_cbranch_scc1 s_c1_ok
    s_add_u32 s46, s46, 1
    s_cmp_gt_u32 s46, 2000000
    s_cbranch_scc1 s_c1_ok
    s_sleep 8
    buffer_load_dword v206, v134, s[20:23], s44 offen sc1
    s_branch s_c1_sp
s_c1_ok:
    s_bitcmp1_b32 s2, 0
    s_cbranch_scc1 s_wo
    s_cmp_lt_u32 s2, 216
    s_cbranch_scc0 s_wo
    s_and_b32 s40, s2, -2
    s_lshl_b32 s40, s40, 4
    s_add_u32 s40, s40, 262144
    s_add_u32 s41, s40, 6912
    s_mov_b32 s42, 0x05040100
    s_mov_b32 s43, 0x07060302
    buffer_load_dword v78, v136, s[20:23], s40 offen sc1
    buffer_load_dword v79, v136, s[20:23], s40 offen offset:3456 sc1
    buffer_load_dword v80, v136, s[20:23], s41 offen sc1
    buffer_load_dword v81, v136, s[20:23], s41 offen offset:3456 sc1
    s_setprio 3
    v_perm_b32 v0, v42, v40, s42
    v_perm_b32 v1, v42, v40, s43
    v_perm_b32 v2, v43, v41, s42
    v_perm_b32 v3, v43, v41, s43
    v_perm_b32 v4, v46, v44, s42
    v_perm_b32 v5, v46, v44, s43
    v_perm_b32 v6, v47, v45, s42
    v_perm_b32 v7, v47, v45, s43
    v_perm_b32 v8, v50, v48, s42
    v_perm_b32 v9, v50, v48, s43
    v_perm_b32 v10, v51, v49, s42
    v_perm_b32 v11, v51, v49, s43
    v_perm_b32 v12, v54, v52, s42
    v_perm_b32 v13, v54, v52, s43
    v_perm_b32 v14, v55, v53, s42
    v_perm_b32 v15, v55, v53, s43
    v_perm_b32 v16, v58, v56, s42
    v_perm_b32 v17, v58, v56, s43
    v_perm_b32 v18, v59, v57, s42
    v_perm_b32 v19, v59, v57, s43
    v_perm_b32 v20, v62, v60, s42
    v_perm_b32 v21, v62, v60, s43
    v_perm_b32 v22, v63, v61, s42
    v_perm_b32 v23, v63, v61, s43
    v_perm_b32 v24, v66, v64, s42
    v_perm_b32 v25, v66, v64, s43
    v_perm_b32 v26, v67, v65, s42
    v_perm_b32 v27, v67, v65, s43
    v_perm_b32 v28, v70, v68, s42
    v_perm_b32 v29, v70, v68, s43
    v_perm_b32 v30, v71, v69, s42
    v_perm_b32 v31, v71, v69, s43
    s_waitcnt vmcnt(0)
    s_setprio 3
    v_mul_f32 v204, 0xbfb8aa3b, v78
    v_mul_f32 v205, 0xbfb8aa3b, v79
    v_exp_f32 v204, v204
    v_exp_f32 v205, v205
    v_pk_mul_f32 v[78:79], v[78:79], v[80:81]
    v_pk_add_f32 v[204:205], v[204:205], 1.0 op_sel_hi:[1,0]
    v_rcp_f32 v204, v204
    v_rcp_f32 v205, v205
    s_bfe_u32 s40, s2, 262145
    v_pk_mul_f32 v[204:205], v[204:205], v[78:79]
    v_cvt_pk_bf16_f32 v205, v204, v205
    s_mul_i32 s40, s40, 2560
    v_readlane_b32 s52, v205, 0
    v_readlane_b32 s53, v205, 1
    v_readlane_b32 s54, v205, 2
    v_readlane_b32 s55, v205, 3
    v_readlane_b32 s56, v205, 4
    v_readlane_b32 s57, v205, 5
    v_readlane_b32 s58, v205, 6
    v_readlane_b32 s59, v205, 7
    s_mul_i32 s41, s7, 160
    s_add_u32 s40, s40, s41
    v_dot2c_f32_bf16 v72, s52, v0
    v_dot2c_f32_bf16 v73, s52, v1
    v_dot2c_f32_bf16 v74, s52, v2
    v_dot2c_f32_bf16 v75, s52, v3
    v_dot2c_f32_bf16 v72, s53, v4
    v_dot2c_f32_bf16 v73, s53, v5
    v_dot2c_f32_bf16 v74, s53, v6
    v_dot2c_f32_bf16 v75, s53, v7
    v_dot2c_f32_bf16 v72, s54, v8
    v_dot2c_f32_bf16 v73, s54, v9
    v_dot2c_f32_bf16 v74, s54, v10
    v_dot2c_f32_bf16 v75, s54, v11
    v_dot2c_f32_bf16 v72, s55, v12
    v_dot2c_f32_bf16 v73, s55, v13
    v_dot2c_f32_bf16 v74, s55, v14
    v_dot2c_f32_bf16 v75, s55, v15
    v_dot2c_f32_bf16 v72, s56, v16
    v_dot2c_f32_bf16 v73, s56, v17
    v_dot2c_f32_bf16 v74, s56, v18
    v_dot2c_f32_bf16 v75, s56, v19
    v_dot2c_f32_bf16 v72, s57, v20
    v_dot2c_f32_bf16 v73, s57, v21
    v_dot2c_f32_bf16 v74, s57, v22
    v_dot2c_f32_bf16 v75, s57, v23
    v_dot2c_f32_bf16 v72, s58, v24
    v_dot2c_f32_bf16 v73, s58, v25
    v_dot2c_f32_bf16 v74, s58, v26
    v_dot2c_f32_bf16 v75, s58, v27
    v_dot2c_f32_bf16 v72, s59, v28
    v_dot2c_f32_bf16 v73, s59, v29
    v_dot2c_f32_bf16 v74, s59, v30
    v_dot2c_f32_bf16 v75, s59, v31
    s_setprio 1
    s_add_u32 s40, s40, 278528
    s_mov_b32 exec_hi, 0xff
    buffer_atomic_add_f32 v72, v132, s[20:23], s40 offen offset:0
    buffer_atomic_add_f32 v73, v132, s[20:23], s40 offen offset:640
    buffer_atomic_add_f32 v74, v132, s[20:23], s40 offen offset:1280
    buffer_atomic_add_f32 v75, v132, s[20:23], s40 offen offset:1920
    s_mov_b32 exec_hi, -1
    s_lshr_b32 s40, s2, 2
    s_lshl_b32 s40, s40, 7
    s_add_u32 s40, s40, 327680
    s_mov_b32 s41, 2
    s_waitcnt vmcnt(0)
    s_atomic_add s41, s[90:91], s40
    s_waitcnt lgkmcnt(0)
s_wo:
    s_mov_b32 s46, 0
    ds_read_b32 v212, v255 offset:0
s_fd_sp:
    s_waitcnt lgkmcnt(0)
    v_cmp_ne_u32 vcc, -1, v212
    s_nop 0
    s_cmp_eq_u64 vcc, 0
    s_cbranch_scc1 s_fd_ok
    s_add_u32 s46, s46, 1
    s_cmp_gt_u32 s46, 2000000
    s_cbranch_scc1 s_fd_ok
    s_sleep 4
    ds_read_b32 v212, v255 offset:0
    s_branch s_fd_sp
s_fd_ok:
    s_lshr_b32 s40, s7, 1
    s_and_b32 s41, s7, 1
    s_mul_i32 s43, s40, 51200
    s_mul_i32 s44, s41, 5120
    s_add_u32 s45, s43, s44
    s_mul_i32 s42, s7, 640
    s_add_u32 s42, s42, 71680
    s_add_u32 s47, s32, 3
    s_mov_b32 exec_hi, 0xff
s_wb:
    s_and_b32 s46, s47, 3
    s_mul_i32 s46, s46, 204800
    s_add_u32 s46, s46, s45
    s_add_u32 s47, s47, 1
    s_add_u32 m0, s42, 0
    s_add_u32 s40, s46, 0
    buffer_load_dwordx4 v201, s[12:15], s40 offen  lds
    s_add_u32 m0, s42, 2560
    s_add_u32 s40, s46, 10240
    buffer_load_dwordx4 v201, s[12:15], s40 offen  lds
    s_add_u32 m0, s42, 5120
    s_add_u32 s40, s46, 102400
    buffer_load_dwordx4 v201, s[12:15], s40 offen  lds
    s_add_u32 m0, s42, 7680
    s_add_u32 s40, s46, 112640
    buffer_load_dwordx4 v201, s[12:15], s40 offen  lds
    s_add_u32 m0, s42, 10240
    s_add_u32 s40, s46, 25600
    buffer_load_dwordx4 v201, s[12:15], s40 offen  lds
    s_add_u32 m0, s42, 12800
    s_add_u32 s40, s46, 35840
    buffer_load_dwordx4 v201, s[12:15], s40 offen  lds
    s_add_u32 m0, s42, 15360
    s_add_u32 s40, s46, 128000
    buffer_load_dwordx4 v201, s[12:15], s40 offen  lds
    s_add_u32 m0, s42, 17920
    s_add_u32 s40, s46, 138240
    buffer_load_dwordx4 v201, s[12:15], s40 offen  lds
    s_add_u32 s42, s42, 20480
    s_mul_i32 s46, s7, 51200
    s_add_u32 m0, s42, 0
    s_add_u32 s40, s46, 20480
    buffer_load_dwordx4 v201, s[12:15], s40 offen  lds
    s_add_u32 m0, s42, 2560
    s_add_u32 s40, s46, 46080
    buffer_load_dwordx4 v201, s[12:15], s40 offen  lds
    s_add_u32 m0, s42, 5120
    s_add_u32 s40, s46, 225280
    buffer_load_dwordx4 v201, s[12:15], s40 offen  lds
    s_add_u32 m0, s42, 7680
    s_add_u32 s40, s46, 250880
    buffer_load_dwordx4 v201, s[12:15], s40 offen  lds
    s_add_u32 m0, s42, 10240
    s_add_u32 s40, s46, 430080
    buffer_load_dwordx4 v201, s[12:15], s40 offen  lds
    s_add_u32 m0, s42, 12800
    s_add_u32 s40, s46, 455680
    buffer_load_dwordx4 v201, s[12:15], s40 offen  lds
    s_add_u32 m0, s42, 15360
    s_add_u32 s40, s46, 634880
    buffer_load_dwordx4 v201, s[12:15], s40 offen  lds
    s_add_u32 m0, s42, 17920
    s_add_u32 s40, s46, 660480
    buffer_load_dwordx4 v201, s[12:15], s40 offen  lds
    s_add_u32 s42, s42, 20480
    s_mov_b32 exec_hi, -1
    s_mov_b64 exec, 0xff
    buffer_load_dword v208, v134, s[68:71], s48 offen sc1
    buffer_load_dword v208, v134, s[68:71], s0 offen sc1
    s_mov_b64 exec, 0xf
    buffer_load_dword v208, v134, s[68:71], s1 offen sc1
    buffer_load_dword v208, v227, s[20:23], s74 offen sc1
    s_mov_b64 exec, -1
    s_mul_i32 s42, s5, 81920
    s_mul_i32 s40, s7, 20480
    s_add_u32 s42, s42, s40
    s_lshl_b32 s40, s62, 11
    s_add_u32 s56, s42, s40
    s_add_u32 s56, s56, 16384
    s_lshl2_add_u32 s42, s40, s42
    s_add_u32 s40, s32, 0
    s_and_b32 s40, s40, 3
    s_lshl_b32 s40, s40, 11
    s_add_u32 s52, s40, s42
    s_add_u32 s40, s32, 1
    s_and_b32 s40, s40, 3
    s_lshl_b32 s40, s40, 11
    s_add_u32 s53, s40, s42
    s_add_u32 s40, s32, 2
    s_and_b32 s40, s40, 3
    s_lshl_b32 s40, s40, 11
    s_add_u32 s54, s40, s42
    s_add_u32 s40, s32, 3
    s_and_b32 s40, s40, 3
    s_lshl_b32 s40, s40, 11
    s_add_u32 s55, s40, s42
    s_waitcnt vmcnt(0)
    s_cmp_lt_u32 s35, 64
    s_cbranch_scc0 s_ny
    s_mov_b32 s44, 327680
    s_mov_b32 s46, 0
    buffer_load_dword v206, v137, s[20:23], s44 offen sc1
s_c2_sp:
    s_waitcnt vmcnt(0)
    v_cmp_ne_u32 vcc, 16, v206
    s_nop 1
    s_cmp_eq_u64 vcc, 0
    s_cbranch_scc1 s_c2_ok
    s_add_u32 s46, s46, 1
    s_cmp_gt_u32 s46, 2000000
    s_cbranch_scc1 s_c2_ok
    s_sleep 16
    buffer_load_dword v206, v137, s[20:23], s44 offen sc1
    s_branch s_c2_sp
s_c2_ok:
    s_mul_i32 s43, s6, 80
    s_mul_i32 s42, s7, 20
    s_add_u32 s43, s43, s42
    s_add_u32 s43, s43, 278528
    buffer_load_dwordx4 v[232:235], v143, s[20:23], s43 offen sc1
    buffer_load_dword v236, v143, s[20:23], s43 offen offset:16 sc1
    s_and_b32 s40, s34, 0xffff8000
    s_or_b32 s40, s40, 0x4000
    s_ashr_i32 s41, s40, 31
    s_not_b32 s41, s41
    s_or_b32 s41, s41, 0x80000000
    s_xor_b32 s40, s40, s41
    s_setprio 3
    v_mov_b32 v206, 0xbfb8aa3b
    v_mul_f32 v206, s40, v206
    v_exp_f32 v206, v206
    s_nop 0
    v_add_f32 v206, 1.0, v206
    v_rcp_f32 v206, v206
    s_waitcnt vmcnt(0)
    v_add_f32_dpp v232, v232, v232 row_ror:8
    v_add_f32_dpp v233, v233, v233 row_ror:8
    v_add_f32_dpp v234, v234, v234 row_ror:8
    v_add_f32_dpp v235, v235, v235 row_ror:8
    v_add_f32_dpp v236, v236, v236 row_ror:8
    v_add_f32_dpp v232, v232, v232 row_ror:4
    v_add_f32_dpp v233, v233, v233 row_ror:4
    v_add_f32_dpp v234, v234, v234 row_ror:4
    v_add_f32_dpp v235, v235, v235 row_ror:4
    v_add_f32_dpp v236, v236, v236 row_ror:4
    v_add_f32_dpp v232, v232, v232 row_ror:2
    v_add_f32_dpp v233, v233, v233 row_ror:2
    v_add_f32_dpp v234, v234, v234 row_ror:2
    v_add_f32_dpp v235, v235, v235 row_ror:2
    v_add_f32_dpp v236, v236, v236 row_ror:2
    v_add_f32_dpp v232, v232, v232 row_ror:1
    v_add_f32_dpp v233, v233, v233 row_ror:1
    v_add_f32_dpp v234, v234, v234 row_ror:1
    v_add_f32_dpp v235, v235, v235 row_ror:1
    v_add_f32_dpp v236, v236, v236 row_ror:1
    v_mul_f32 v232, v232, v206
    ds_write_b32 v139, v232 offset:2816
    v_mul_f32 v233, v233, v206
    ds_write_b32 v139, v233 offset:2832
    v_mul_f32 v234, v234, v206
    ds_write_b32 v139, v234 offset:2848
    v_mul_f32 v235, v235, v206
    ds_write_b32 v139, v235 offset:2864
    v_mul_f32 v236, v236, v206
    ds_write_b32 v139, v236 offset:2880
s_ny:
    s_setprio 3
    s_waitcnt lgkmcnt(0)
    v_sub_f32 v204, 1.0, v228
    v_lshlrev_b32 v232, 16, v216
    v_and_b32 v233, 0xffff0000, v216
    v_lshlrev_b32 v234, 16, v217
    v_and_b32 v235, 0xffff0000, v217
    v_lshlrev_b32 v236, 16, v218
    v_and_b32 v237, 0xffff0000, v218
    v_lshlrev_b32 v238, 16, v219
    v_and_b32 v239, 0xffff0000, v219
    v_lshlrev_b32 v240, 16, v220
    v_and_b32 v241, 0xffff0000, v220
    v_lshlrev_b32 v242, 16, v221
    v_and_b32 v243, 0xffff0000, v221
    v_lshlrev_b32 v244, 16, v222
    v_and_b32 v245, 0xffff0000, v222
    v_lshlrev_b32 v246, 16, v223
    v_and_b32 v247, 0xffff0000, v223
    v_lshlrev_b32 v248, 16, v224
    v_and_b32 v249, 0xffff0000, v224
    v_lshlrev_b32 v250, 16, v225
    v_and_b32 v251, 0xffff0000, v225
    v_pk_mul_f32 v[232:233], v[232:233], v[204:205] op_sel_hi:[1,0]
    v_pk_mul_f32 v[234:235], v[234:235], v[204:205] op_sel_hi:[1,0]
    v_pk_mul_f32 v[236:237], v[236:237], v[204:205] op_sel_hi:[1,0]
    v_pk_mul_f32 v[238:239], v[238:239], v[204:205] op_sel_hi:[1,0]
    v_pk_mul_f32 v[240:241], v[240:241], v[204:205] op_sel_hi:[1,0]
    v_pk_mul_f32 v[242:243], v[242:243], v[204:205] op_sel_hi:[1,0]
    v_pk_mul_f32 v[244:245], v[244:245], v[204:205] op_sel_hi:[1,0]
    v_pk_mul_f32 v[246:247], v[246:247], v[204:205] op_sel_hi:[1,0]
    v_pk_mul_f32 v[248:249], v[248:249], v[204:205] op_sel_hi:[1,0]
    v_pk_mul_f32 v[250:251], v[250:251], v[204:205] op_sel_hi:[1,0]
    s_nop 0
    s_setprio 0
    s_waitcnt lgkmcnt(0)
    s_barrier
    ds_read_b64_tr_b16 v[0:1], v209 offset:0
    ds_read_b64_tr_b16 v[2:3], v209 offset:2560
    ds_read_b64_tr_b16 v[4:5], v209 offset:32
    ds_read_b64_tr_b16 v[6:7], v209 offset:2592
    ds_read_b64_tr_b16 v[8:9], v209 offset:64
    ds_read_b64_tr_b16 v[10:11], v209 offset:2624
    ds_read_b64_tr_b16 v[12:13], v209 offset:96
    ds_read_b64_tr_b16 v[14:15], v209 offset:2656
    ds_read_b64_tr_b16 v[16:17], v209 offset:128
    ds_read_b64_tr_b16 v[18:19], v209 offset:2688
    ds_read_b64_tr_b16 v[20:21], v209 offset:5120
    ds_read_b64_tr_b16 v[22:23], v209 offset:7680
    ds_read_b64_tr_b16 v[24:25], v209 offset:5152
    ds_read_b64_tr_b16 v[26:27], v209 offset:7712
    ds_read_b64_tr_b16 v[28:29], v209 offset:5184
    ds_read_b64_tr_b16 v[30:31], v209 offset:7744
    ds_read_b64_tr_b16 v[32:33], v209 offset:5216
    ds_read_b64_tr_b16 v[34:35], v209 offset:7776
    ds_read_b64_tr_b16 v[36:37], v209 offset:5248
    ds_read_b64_tr_b16 v[38:39], v209 offset:7808
    ds_read_b64_tr_b16 v[40:41], v209 offset:20480
    ds_read_b64_tr_b16 v[42:43], v209 offset:23040
    ds_read_b64_tr_b16 v[44:45], v209 offset:20512
    ds_read_b64_tr_b16 v[46:47], v209 offset:23072
    ds_read_b64_tr_b16 v[48:49], v209 offset:20544
    ds_read_b64_tr_b16 v[50:51], v209 offset:23104
    ds_read_b64_tr_b16 v[52:53], v209 offset:20576
    ds_read_b64_tr_b16 v[54:55], v209 offset:23136
    ds_read_b64_tr_b16 v[56:57], v209 offset:20608
    ds_read_b64_tr_b16 v[58:59], v209 offset:23168
    ds_read_b64_tr_b16 v[60:61], v209 offset:25600
    ds_read_b64_tr_b16 v[62:63], v209 offset:28160
    ds_read_b64_tr_b16 v[64:65], v209 offset:25632
    ds_read_b64_tr_b16 v[66:67], v209 offset:28192
    ds_read_b64_tr_b16 v[68:69], v209 offset:25664
    ds_read_b64_tr_b16 v[70:71], v209 offset:28224
    ds_read_b64_tr_b16 v[72:73], v209 offset:25696
    ds_read_b64_tr_b16 v[74:75], v209 offset:28256
    ds_read_b64_tr_b16 v[76:77], v209 offset:25728
    ds_read_b64_tr_b16 v[78:79], v209 offset:28288
    ds_read_b64_tr_b16 v[80:81], v209 offset:40960
    ds_read_b64_tr_b16 v[82:83], v209 offset:43520
    ds_read_b64_tr_b16 v[84:85], v209 offset:40992
    ds_read_b64_tr_b16 v[86:87], v209 offset:43552
    ds_read_b64_tr_b16 v[88:89], v209 offset:41024
    ds_read_b64_tr_b16 v[90:91], v209 offset:43584
    ds_read_b64_tr_b16 v[92:93], v209 offset:41056
    ds_read_b64_tr_b16 v[94:95], v209 offset:43616
    ds_read_b64_tr_b16 v[96:97], v209 offset:41088
    ds_read_b64_tr_b16 v[98:99], v209 offset:43648
    ds_read_b64_tr_b16 v[100:101], v209 offset:46080
    ds_read_b64_tr_b16 v[102:103], v209 offset:48640
    ds_read_b64_tr_b16 v[104:105], v209 offset:46112
    ds_read_b64_tr_b16 v[106:107], v209 offset:48672
    ds_read_b64_tr_b16 v[108:109], v209 offset:46144
    ds_read_b64_tr_b16 v[110:111], v209 offset:48704
    ds_read_b64_tr_b16 v[112:113], v209 offset:46176
    ds_read_b64_tr_b16 v[114:115], v209 offset:48736
    ds_read_b64_tr_b16 v[116:117], v209 offset:46208
    ds_read_b64_tr_b16 v[118:119], v209 offset:48768
    ds_read_b64_tr_b16 v[160:161], v210 offset:0
    ds_read_b64_tr_b16 v[162:163], v210 offset:2560
    ds_read_b64_tr_b16 v[164:165], v210 offset:32
    ds_read_b64_tr_b16 v[166:167], v210 offset:2592
    ds_read_b64_tr_b16 v[168:169], v210 offset:64
    ds_read_b64_tr_b16 v[170:171], v210 offset:2624
    ds_read_b64_tr_b16 v[172:173], v210 offset:96
    ds_read_b64_tr_b16 v[174:175], v210 offset:2656
    ds_read_b64_tr_b16 v[176:177], v210 offset:128
    ds_read_b64_tr_b16 v[178:179], v210 offset:2688
    ds_read_b64_tr_b16 v[180:181], v210 offset:5120
    ds_read_b64_tr_b16 v[182:183], v210 offset:7680
    ds_read_b64_tr_b16 v[184:185], v210 offset:5152
    ds_read_b64_tr_b16 v[186:187], v210 offset:7712
    ds_read_b64_tr_b16 v[188:189], v210 offset:5184
    ds_read_b64_tr_b16 v[190:191], v210 offset:7744
    ds_read_b64_tr_b16 v[192:193], v210 offset:5216
    ds_read_b64_tr_b16 v[194:195], v210 offset:7776
    ds_read_b64_tr_b16 v[196:197], v210 offset:5248
    ds_read_b64_tr_b16 v[198:199], v210 offset:7808
    s_lshr_b32 s40, s35, 4
    s_cmp_eq_u32 s40, s7
    s_cbranch_scc0 s_ny2
    s_and_b32 s40, s35, 15
    s_lshl_b32 s40, 0x10001, s40
    s_mov_b32 exec_lo, s40
    s_mov_b32 exec_hi, s40
    ds_read_b128 v[120:123], v141 offset:2816
    ds_read_b128 v[124:127], v141 offset:2880
    ds_read_b128 v[144:147], v141 offset:2944
    ds_read_b128 v[148:151], v141 offset:3008
    ds_read_b128 v[156:159], v141 offset:3072
    s_waitcnt lgkmcnt(0)
    v_pk_fma_f32 v[232:233], v[120:121], v[204:205], v[232:233] op_sel_hi:[1,0,1]
    v_pk_fma_f32 v[234:235], v[122:123], v[204:205], v[234:235] op_sel_hi:[1,0,1]
    v_pk_fma_f32 v[236:237], v[124:125], v[204:205], v[236:237] op_sel_hi:[1,0,1]
    v_pk_fma_f32 v[238:239], v[126:127], v[204:205], v[238:239] op_sel_hi:[1,0,1]
    v_pk_fma_f32 v[240:241], v[144:145], v[204:205], v[240:241] op_sel_hi:[1,0,1]
    v_pk_fma_f32 v[242:243], v[146:147], v[204:205], v[242:243] op_sel_hi:[1,0,1]
    v_pk_fma_f32 v[244:245], v[148:149], v[204:205], v[244:245] op_sel_hi:[1,0,1]
    v_pk_fma_f32 v[246:247], v[150:151], v[204:205], v[246:247] op_sel_hi:[1,0,1]
    v_pk_fma_f32 v[248:249], v[156:157], v[204:205], v[248:249] op_sel_hi:[1,0,1]
    v_pk_fma_f32 v[250:251], v[158:159], v[204:205], v[250:251] op_sel_hi:[1,0,1]
    s_mov_b64 exec, -1
s_ny2:
    s_setprio 1
    s_waitcnt lgkmcnt(0)
    s_barrier
    ds_read_b32 v212, v255 offset:32
    s_setprio 3
    buffer_load_dwordx4 v[120:123], v200, s[68:71], s52 offen offset:0 sc1
    buffer_load_dwordx4 v[124:127], v200, s[68:71], s52 offen offset:1024 sc1
    buffer_load_dwordx4 v[144:147], v200, s[68:71], s53 offen offset:0 sc1
    buffer_load_dwordx4 v[148:151], v200, s[68:71], s53 offen offset:1024 sc1
    s_mov_b32 s46, 0
    s_waitcnt lgkmcnt(0)
    v_cmp_ne_u32 vcc, 0, v212
    s_nop 0
    s_cmp_lg_u64 vcc, 0
    s_cbranch_scc1 a_exact
    s_setprio 2
    buffer_load_dwordx4 v[152:155], v200, s[68:71], s54 offen offset:0 sc1
    buffer_load_dwordx4 v[156:159], v200, s[68:71], s54 offen offset:1024 sc1
    s_waitcnt vmcnt(4)
    v_max3_u32 v204, v120, v121, v122
    v_max3_u32 v205, v123, v124, v125
    v_max3_u32 v204, v204, v126, v127
    v_max_u32 v204, v204, v205
    v_cmp_eq_u32 vcc, -1, v204
    s_nop 0
    s_cmp_eq_u64 vcc, 0
    s_cbranch_scc0 s_r0
    v_mfma_f32_16x16x32_bf16 v[232:235], v[0:3], v[120:123], v[232:235]
    buffer_load_dwordx4 v[136:139], v200, s[68:71], s55 offen offset:0 sc1
    v_mfma_f32_16x16x32_bf16 v[236:239], v[4:7], v[120:123], v[236:239]
    buffer_load_dwordx4 v[140:143], v200, s[68:71], s55 offen offset:1024 sc1
    v_mfma_f32_16x16x32_bf16 v[240:243], v[8:11], v[120:123], v[240:243]
    buffer_load_dwordx4 v[128:131], v200, s[68:71], s56 offen offset:0 sc1
    v_mfma_f32_16x16x32_bf16 v[244:247], v[12:15], v[120:123], v[244:247]
    buffer_load_dwordx4 v[132:135], v200, s[68:71], s56 offen offset:1024 sc1
    v_mfma_f32_16x16x32_bf16 v[248:251], v[16:19], v[120:123], v[248:251]
    v_mfma_f32_16x16x32_bf16 v[232:235], v[20:23], v[124:127], v[232:235]
    s_waitcnt lgkmcnt(0)
    s_branch t_m6
s_r0:
    buffer_load_dwordx4 v[136:139], v200, s[68:71], s55 offen offset:0 sc1
    buffer_load_dwordx4 v[140:143], v200, s[68:71], s55 offen offset:1024 sc1
    buffer_load_dwordx4 v[128:131], v200, s[68:71], s56 offen offset:0 sc1
    buffer_load_dwordx4 v[132:135], v200, s[68:71], s56 offen offset:1024 sc1
    s_waitcnt lgkmcnt(0)
    s_branch t_r0
k_last:
a_exact:
    s_mov_b32 s37, 1
    s_waitcnt vmcnt(0) lgkmcnt(0)
    s_barrier
    s_cmp_eq_u32 s3, 0
    s_cbranch_scc1 x_c
    s_mul_i32 s46, s7, 5120
    s_mov_b32 s42, s46
    s_and_b32 s45, s2, 7
    s_mov_b32 m0, s42
    s_mul_i32 s40, s45, 20480
    s_add_u32 s40, s40, s46
    buffer_load_dwordx4 v200, s[20:23], s40 offen sc1 lds
    buffer_load_dwordx4 v200, s[20:23], s40 offen offset:1024 sc1 lds
    buffer_load_dwordx4 v200, s[20:23], s40 offen offset:2048 sc1 lds
    buffer_load_dwordx4 v200, s[20:23], s40 offen offset:3072 sc1 lds
    s_add_u32 m0, m0, 4096
    s_add_u32 s40, s40, 4096
    buffer_load_dwordx4 v200, s[20:23], s40 offen sc1 lds
    s_add_u32 s42, s46, 20480
    s_add_u32 s43, s6, 0
x_r:
    s_cmp_ge_u32 s43, 7
    s_cselect_b32 s45, 7, 0
    s_sub_u32 s43, s43, s45
    s_add_u32 s43, s43, 1
    s_add_u32 s45, s2, s43
    s_and_b32 s45, s45, 7
    s_mov_b32 m0, s42
    s_mul_i32 s40, s45, 20480
    s_add_u32 s40, s40, s46
    buffer_load_dwordx4 v200, s[20:23], s40 offen sc1 lds
    buffer_load_dwordx4 v200, s[20:23], s40 offen offset:1024 sc1 lds
    buffer_load_dwordx4 v200, s[20:23], s40 offen offset:2048 sc1 lds
    buffer_load_dwordx4 v200, s[20:23], s40 offen offset:3072 sc1 lds
    s_add_u32 m0, m0, 4096
    s_add_u32 s40, s40, 4096
    buffer_load_dwordx4 v200, s[20:23], s40 offen sc1 lds
    s_add_u32 s42, s42, 20480
    s_cmp_lt_u32 s42, 163840
    s_cbranch_scc1 x_r
    s_setprio 1
    s_waitcnt vmcnt(0)
    s_barrier
    s_barrier
    s_cmp_eq_u32 s4, 7
    s_cbranch_scc0 x_p
    v_mov_b64 v[48:49], 0
    v_mov_b64 v[50:51], 0
    v_add_u32 v204, 112640, v200
    v_mul_u32_u24 v205, 320, v231
    v_add_u32 v205, 112960, v205
    v_mov_b32 v52, 0x3f803f80
    v_mov_b32 v53, 0x3f803f80
    v_mov_b64 v[54:55], v[52:53]
    ds_write_b128 v204, v[48:51]
    ds_write_b128 v204, v[48:51] offset:1024
    ds_write_b128 v204, v[48:51] offset:2048
    s_mov_b64 exec, 0xff
    ds_write_b128 v205, v[52:55]
    s_mov_b64 exec, -1
x_p:
    s_waitcnt lgkmcnt(0)
    s_barrier
    ds_write_b32 v135, v128 offset:16
    s_branch s_s1
x_c:
    v_and_b32 v205, 31, v231
    v_lshrrev_b32 v206, 5, v231
    v_mul_u32_u24 v206, 5120, v206
    v_lshl_add_u32 v169, v205, 4, v206
    v_mov_b32 v168, 0xdddd
    v_cmp_gt_u32 vcc, 20, v205
    v_lshlrev_b32 v206, 4, v205
    v_add_u32 v206, 110592, v206
    v_cndmask_b32 v138, v206, v169, vcc
    v_cndmask_b32 v139, 0, 1, vcc
    v_mov_b64 v[64:65], 0
    v_mov_b64 v[66:67], 0
    v_mov_b64 v[68:69], 0
    v_mov_b64 v[70:71], 0
    v_mov_b64 v[72:73], 0
    v_mov_b64 v[74:75], 0
    v_mov_b64 v[76:77], 0
    v_mov_b64 v[78:79], 0
    v_mov_b64 v[80:81], 0
    v_mov_b64 v[82:83], 0
    v_mov_b64 v[84:85], 0
    v_mov_b64 v[86:87], 0
    v_mov_b64 v[88:89], 0
    v_mov_b64 v[90:91], 0
    v_mov_b64 v[92:93], 0
    v_mov_b64 v[94:95], 0
    v_mov_b32 v207, v169
    v_mov_b32 v208, 0xff800000
    v_mov_b32 v209, 0xff800000
    s_mov_b32 s40, 0
    s_setprio 2
    s_barrier
x_mx:
    ds_read_b128 v[140:143], v207 offset:0
    ds_read_b128 v[144:147], v207 offset:1024
    ds_read_b128 v[148:151], v207 offset:4608
    s_waitcnt lgkmcnt(0)
    v_mfma_f32_32x32x4_2b_bf16 v[0:31], v[148:149], v[136:137], 0 cbsz:1 abid:0
    v_mfma_f32_32x32x4_2b_bf16 v[32:63], v[150:151], v[136:137], 0 cbsz:1 abid:0
    s_nop 15
    s_nop 1
    v_mfma_f32_32x32x16_bf16 v[0:15], v[140:143], v[128:131], v[0:15]
    v_mfma_f32_32x32x16_bf16 v[16:31], v[140:143], v[132:135], v[16:31]
    v_mfma_f32_32x32x16_bf16 v[32:47], v[144:147], v[128:131], v[32:47]
    v_mfma_f32_32x32x16_bf16 v[48:63], v[144:147], v[132:135], v[48:63]
    s_nop 11
    v_max3_f32 v208, v208, v0, v32
    v_max3_f32 v209, v209, v16, v48
    v_max3_f32 v208, v208, v1, v33
    v_max3_f32 v209, v209, v17, v49
    v_max3_f32 v208, v208, v2, v34
    v_max3_f32 v209, v209, v18, v50
    v_max3_f32 v208, v208, v3, v35
    v_max3_f32 v209, v209, v19, v51
    v_max3_f32 v208, v208, v4, v36
    v_max3_f32 v209, v209, v20, v52
    v_max3_f32 v208, v208, v5, v37
    v_max3_f32 v209, v209, v21, v53
    v_max3_f32 v208, v208, v6, v38
    v_max3_f32 v209, v209, v22, v54
    v_max3_f32 v208, v208, v7, v39
    v_max3_f32 v209, v209, v23, v55
    v_max3_f32 v208, v208, v8, v40
    v_max3_f32 v209, v209, v24, v56
    v_max3_f32 v208, v208, v9, v41
    v_max3_f32 v209, v209, v25, v57
    v_max3_f32 v208, v208, v10, v42
    v_max3_f32 v209, v209, v26, v58
    v_max3_f32 v208, v208, v11, v43
    v_max3_f32 v209, v209, v27, v59
    v_max3_f32 v208, v208, v12, v44
    v_max3_f32 v209, v209, v28, v60
    v_max3_f32 v208, v208, v13, v45
    v_max3_f32 v209, v209, v29, v61
    v_max3_f32 v208, v208, v14, v46
    v_max3_f32 v209, v209, v30, v62
    v_max3_f32 v208, v208, v15, v47
    v_max3_f32 v209, v209, v31, v63
    ds_read_b128 v[140:143], v207 offset:512
    ds_read_b128 v[144:147], v207 offset:1536
    ds_read_b128 v[148:151], v207 offset:4608
    s_waitcnt lgkmcnt(0)
    v_mfma_f32_32x32x4_2b_bf16 v[0:31], v[148:149], v[136:137], 0 cbsz:1 abid:1
    v_mfma_f32_32x32x4_2b_bf16 v[32:63], v[150:151], v[136:137], 0 cbsz:1 abid:1
    s_nop 15
    s_nop 1
    v_mfma_f32_32x32x16_bf16 v[0:15], v[140:143], v[128:131], v[0:15]
    v_mfma_f32_32x32x16_bf16 v[16:31], v[140:143], v[132:135], v[16:31]
    v_mfma_f32_32x32x16_bf16 v[32:47], v[144:147], v[128:131], v[32:47]
    v_mfma_f32_32x32x16_bf16 v[48:63], v[144:147], v[132:135], v[48:63]
    s_nop 11
    v_max3_f32 v208, v208, v0, v32
    v_max3_f32 v209, v209, v16, v48
    v_max3_f32 v208, v208, v1, v33
    v_max3_f32 v209, v209, v17, v49
    v_max3_f32 v208, v208, v2, v34
    v_max3_f32 v209, v209, v18, v50
    v_max3_f32 v208, v208, v3, v35
    v_max3_f32 v209, v209, v19, v51
    v_max3_f32 v208, v208, v4, v36
    v_max3_f32 v209, v209, v20, v52
    v_max3_f32 v208, v208, v5, v37
    v_max3_f32 v209, v209, v21, v53
    v_max3_f32 v208, v208, v6, v38
    v_max3_f32 v209, v209, v22, v54
    v_max3_f32 v208, v208, v7, v39
    v_max3_f32 v209, v209, v23, v55
    v_max3_f32 v208, v208, v8, v40
    v_max3_f32 v209, v209, v24, v56
    v_max3_f32 v208, v208, v9, v41
    v_max3_f32 v209, v209, v25, v57
    v_max3_f32 v208, v208, v10, v42
    v_max3_f32 v209, v209, v26, v58
    v_max3_f32 v208, v208, v11, v43
    v_max3_f32 v209, v209, v27, v59
    v_max3_f32 v208, v208, v12, v44
    v_max3_f32 v209, v209, v28, v60
    v_max3_f32 v208, v208, v13, v45
    v_max3_f32 v209, v209, v29, v61
    v_max3_f32 v208, v208, v14, v46
    v_max3_f32 v209, v209, v30, v62
    v_max3_f32 v208, v208, v15, v47
    v_max3_f32 v209, v209, v31, v63
    v_add_u32 v207, 10240, v207
    s_add_u32 s40, s40, 1
    s_cmp_lt_u32 s40, 16
    s_cbranch_scc1 x_mx
    s_barrier
    s_barrier
    v_mov_b64 v[0:1], v[208:209]
    ds_read_b128 v[148:151], v169 offset:4608
    ds_read_b128 v[140:143], v169
    v_permlane32_swap_b32 v0, v208
    v_permlane32_swap_b32 v1, v209
    v_max_f32 v0, v0, v208
    v_max_f32 v1, v1, v209
    v_sub_f32 v96, 0, v0
    v_sub_f32 v112, 0, v1
    v_sub_f32 v97, 0, v0
    v_sub_f32 v113, 0, v1
    v_sub_f32 v98, 0, v0
    v_sub_f32 v114, 0, v1
    v_sub_f32 v99, 0, v0
    v_sub_f32 v115, 0, v1
    v_sub_f32 v100, 0, v0
    v_sub_f32 v116, 0, v1
    v_sub_f32 v101, 0, v0
    v_sub_f32 v117, 0, v1
    v_sub_f32 v102, 0, v0
    v_sub_f32 v118, 0, v1
    v_sub_f32 v103, 0, v0
    v_sub_f32 v119, 0, v1
    v_sub_f32 v104, 0, v0
    v_sub_f32 v120, 0, v1
    v_sub_f32 v105, 0, v0
    v_sub_f32 v121, 0, v1
    v_sub_f32 v106, 0, v0
    v_sub_f32 v122, 0, v1
    v_sub_f32 v107, 0, v0
    v_sub_f32 v123, 0, v1
    v_sub_f32 v108, 0, v0
    v_sub_f32 v124, 0, v1
    v_sub_f32 v109, 0, v0
    v_sub_f32 v125, 0, v1
    v_sub_f32 v110, 0, v0
    v_sub_f32 v126, 0, v1
    v_sub_f32 v111, 0, v0
    v_sub_f32 v127, 0, v1
    ds_read_b128 v[152:155], v138 offset:2048
    ds_read_b128 v[156:159], v138 offset:2368
    ds_read_b128 v[144:147], v169 offset:512
    s_waitcnt lgkmcnt(0)
    v_mfma_f32_32x32x4_2b_bf16 v[0:31], v[148:149], v[136:137], v[96:127] cbsz:1 abid:0
    s_nop 15
    s_nop 1
    v_mfma_f32_32x32x16_bf16 v[0:15], v[140:143], v[128:131], v[0:15]
    v_mfma_f32_32x32x16_bf16 v[16:31], v[140:143], v[132:135], v[16:31]
    s_lshl2_add_u32 s40, s7, 112640
    v_mov_b32 v206, -1
    v_mov_b32 v207, s40
    s_nop 11
    v_exp_f32 v0, v0
    v_exp_f32 v1, v1
    s_branch a_in
.section .rodata,"a"
.p2align 6
.amdhsa_kernel gated_mix__grouped_kv_mqa__moe_arch_mod__prompt_kernel
  .amdhsa_next_free_vgpr 256
  .amdhsa_next_free_sgpr 102
  .amdhsa_accum_offset 256
  .amdhsa_group_segment_fixed_size 0
  .amdhsa_kernarg_size 112
  .amdhsa_user_sgpr_count 2
  .amdhsa_user_sgpr_kernarg_segment_ptr 1
  .amdhsa_system_sgpr_workgroup_id_x 1
  .amdhsa_float_denorm_mode_32 3
.end_amdhsa_kernel
```
